```python
import torch

def _softmax(x, axis=-1):
    return torch.softmax(x, dim=axis)
def _gelu(x):
    return torch.nn.functional.gelu(x, approximate="tanh")
def _silu(x):
    return torch.nn.functional.silu(x)
def _sigmoid(x):
    return torch.sigmoid(x)
def _layernorm(x, axis=-1, eps=1e-5):
    m = x.mean(dim=axis, keepdim=True)
    v = x.var(dim=axis, keepdim=True, unbiased=False)
    return (x - m) / torch.sqrt(v + eps)
def _scatter_add(tgt, idx, src, axis=0):
    return tgt.clone().index_add_(axis, idx, src)
def _segment_sum(src, seg, n):
    out = torch.zeros((n,) + src.shape[1:], dtype=src.dtype)
    return out.index_add_(0, seg, src)
def _pad(x, pw):
    flat = tuple(v for pair in reversed(pw) for v in pair)
    return torch.nn.functional.pad(x, flat)

kernel_name = 'standalone__gqa_block_cached__sampling'

def setup_inputs():

    _w = (lambda a: (lambda t: t.to(torch.bfloat16) if t.is_floating_point() else t)(torch.as_tensor(a)))
    B, Sq, D = 8, 16, 448
    Hq, Hkv, Sk, Dh = 16, 8, 2048, 256
    assert Hq % Hkv == 0, (Hq, Hkv)
    return {
        "x": _w((lambda *s: torch.randn(*s, dtype=torch.bfloat16) * 0.8)(B, Sq, D)),
        "k_cache": _w((lambda *s: torch.randn(*s, dtype=torch.bfloat16) * 0.8)(B, Hkv, Sk, Dh)),
        "v_cache": _w((lambda *s: torch.randn(*s, dtype=torch.bfloat16) * 0.05)(B, Hkv, Sk, Dh)),
        "wq": _w((lambda *s: torch.randn(*s, dtype=torch.bfloat16) * 0.8)(D, Hq * Dh) * (D ** -0.5)),
        "wo": _w((lambda *s: torch.randn(*s, dtype=torch.bfloat16) * 0.05)(Hq * Dh, D) * ((Hq * Dh) ** -0.5)),
    }

def reference(x, k_cache, v_cache, wq, wo):
    B, Sq, D = x.shape
    Hq, Dh = 16, 256
    Hkv = k_cache.shape[1]
    rep = Hq // Hkv
    q = (lambda x, *d: x.permute(*d))((x @ wq).reshape(B, Sq, Hq, Dh), 0, 2, 1, 3)
    k = (lambda x, n, axis: torch.repeat_interleave(x, n, dim=axis))(k_cache, rep, axis=1)
    v = (lambda x, n, axis: torch.repeat_interleave(x, n, dim=axis))(v_cache, rep, axis=1)
    scores = torch.einsum("bhqd,bhkd->bhqk", q, k) * (Dh ** -0.5)
    p = _softmax(scores, axis=-1)
    o = torch.einsum("bhqk,bhkd->bhqd", p, v)
    return (lambda x, *d: x.permute(*d))(o, 0, 2, 1, 3).reshape(B, Sq, Hq * Dh) @ wo
```

```asm
; @launch grid=(256,1,1) block=(256,1,1) lds=157696
.amdgcn_target "amdgcn-amd-amdhsa--gfx950"
.text
.globl standalone__gqa_block_cached__sampling_kernel
.p2align 8
.type standalone__gqa_block_cached__sampling_kernel,@function
standalone__gqa_block_cached__sampling_kernel:
    s_cmp_ge_u32 s2, 256
    s_cbranch_scc1 L_exitA
    s_load_dwordx16 s[4:19], s[0:1], 0
    v_lshrrev_b32 v1, 6, v0
    v_and_b32 v0, 63, v0
    s_and_b32 s49, s2, 7
    v_readfirstlane_b32 s48, v1
    s_lshr_b32 s50, s2, 3
    s_and_b32 s50, s50, 3
    s_lshr_b32 s51, s2, 5
    s_mov_b32 s60, 0x05040100
    s_mov_b32 s61, 0x07060302
    s_mov_b32 s94, 0
    v_lshrrev_b32 v26, 5, v0
    v_and_b32 v27, 31, v0
    v_xor_b32 v28, v27, v26
    v_lshlrev_b32 v28, 4, v28
    v_lshl_add_u32 v1, v26, 9, v28
    v_xor_b32 v2, 32, v1
    v_xor_b32 v3, 64, v1
    v_xor_b32 v4, 96, v1
    v_xor_b32 v5, 128, v1
    v_xor_b32 v6, 160, v1
    v_xor_b32 v7, 192, v1
    v_xor_b32 v8, 224, v1
    v_lshrrev_b32 v28, 3, v0
    v_and_b32 v29, 7, v0
    v_bfe_u32 v30, v0, 4, 1
    v_lshlrev_b32 v30, 2, v30
    v_xor_b32 v29, v29, v30
    v_lshlrev_b32 v29, 4, v29
    v_lshl_add_u32 v9, v28, 9, v29
    s_lshl_b32 s54, s48, 7
    v_add_u32 v9, s54, v9
    s_mul_i32 s52, s48, 30720
    v_lshrrev_b32 v28, 5, v0
    v_bfe_u32 v29, v0, 2, 2
    v_lshl_add_u32 v28, v28, 2, v29
    v_bfe_u32 v29, v28, 1, 1
    v_lshlrev_b32 v29, 6, v29
    v_lshl_add_u32 v29, v28, 7, v29
    v_bfe_u32 v30, v0, 4, 1
    v_lshl_add_u32 v29, v30, 5, v29
    v_and_b32 v30, 3, v0
    v_lshl_add_u32 v29, v30, 3, v29
    v_add_u32 v10, s52, v29
    v_xor_b32 v11, 64, v10
    v_lshlrev_b32 v28, 4, v0
    v_add_u32 v12, 122880, v28
    s_lshl_b32 s54, s48, 13
    v_add_u32 v13, s54, v12
    v_and_b32 v28, 15, v27
    v_xor_b32 v28, v28, v26
    v_lshlrev_b32 v28, 4, v28
    v_and_b32 v29, 1, v27
    v_lshl_add_u32 v28, v29, 9, v28
    v_add_u32 v16, s52, v28
    v_lshrrev_b32 v17, 1, v27
    v_lshrrev_b32 v28, 4, v0
    v_and_b32 v29, 15, v0
    v_lshlrev_b32 v30, 16, v28
    v_lshl_add_u32 v30, v29, 4, v30
    s_lshl_b32 s54, s48, 8
    v_add_u32 v14, s54, v30
    v_mul_u32_u24 v30, 896, v29
    v_lshl_add_u32 v15, v28, 4, v30
    v_lshrrev_b32 v28, 4, v0
    v_and_b32 v29, 15, v0
    v_lshlrev_b32 v30, 16, v28
    v_lshl_add_u32 v30, v29, 4, v30
    s_lshl_b32 s54, s48, 18
    v_add_u32 v14, s54, v30
    s_lshl_b32 s57, s51, 8
    s_add_u32 s57, s57, 0x1000000
    s_lshl_b32 s54, s51, 2
    s_add_u32 s54, s54, s50
    s_lshl_b32 s54, s54, 2
    s_add_u32 s54, s54, s48
    s_mul_i32 s54, s54, 28
    v_min_u32 v28, 27, v0
    v_add_u32 v28, s54, v28
    v_lshrrev_b32 v29, 3, v28
    v_lshlrev_b32 v29, 13, v29
    v_and_b32 v30, 7, v28
    v_lshl_add_u32 v29, v30, 7, v29
    s_lshl_b32 s55, s49, 10
    v_add_u32 v29, s55, v29
    v_lshlrev_b32 v28, 7, v28
    s_mul_i32 s55, s49, 458752
    v_add_u32 v28, s55, v28
    s_lshl_b32 s56, s51, 3
    s_add_u32 s56, s56, s49
    s_lshl_b32 s56, s56, 2
    s_add_u32 s56, s56, s50
    s_lshl_b32 s56, s56, 2
    s_add_u32 s56, s56, s48
    s_lshl_b32 s56, s56, 16
    s_waitcnt lgkmcnt(0)
    global_load_dword v30, v29, s[10:11]
    global_load_dword v31, v28, s[12:13]
    s_add_u32 s20, s6, s56
    s_addc_u32 s21, s7, 0
    s_mov_b32 s22, 0x10000
    s_mov_b32 s23, 0x00020000
    s_load_dword s63, s[18:19], s57
    s_add_u32 m0, s52, 0
    s_mov_b32 s53, 0
    buffer_load_dwordx4 v1, s[20:23], s53 offen nt lds
    s_add_u32 m0, s52, 1024
    s_mov_b32 s53, 1024
    buffer_load_dwordx4 v2, s[20:23], s53 offen nt lds
    s_add_u32 m0, s52, 2048
    s_mov_b32 s53, 2048
    buffer_load_dwordx4 v3, s[20:23], s53 offen nt lds
    s_add_u32 m0, s52, 3072
    s_mov_b32 s53, 3072
    buffer_load_dwordx4 v4, s[20:23], s53 offen nt lds
    s_add_u32 m0, s52, 4096
    s_mov_b32 s53, 4096
    buffer_load_dwordx4 v5, s[20:23], s53 offen nt lds
    s_add_u32 m0, s52, 5120
    s_mov_b32 s53, 5120
    buffer_load_dwordx4 v6, s[20:23], s53 offen nt lds
    s_add_u32 m0, s52, 6144
    s_mov_b32 s53, 6144
    buffer_load_dwordx4 v7, s[20:23], s53 offen nt lds
    s_add_u32 m0, s52, 7168
    s_mov_b32 s53, 7168
    buffer_load_dwordx4 v8, s[20:23], s53 offen nt lds
    s_lshl_b32 s54, s51, 3
    s_add_u32 s54, s54, s49
    s_lshl_b32 s54, s54, 20
    s_lshl_b32 s55, s50, 18
    s_add_u32 s54, s54, s55
    s_add_u32 s24, s8, s54
    s_addc_u32 s25, s9, 0
    s_mov_b32 s26, 0x40000
    s_mov_b32 s27, 0x00020000
    s_lshl_b32 s55, s48, 16
    s_add_u32 s54, s54, s55
    s_add_u32 s20, s6, s54
    s_addc_u32 s21, s7, 0
    s_mov_b32 s22, 0x10000
    s_mov_b32 s23, 0x00020000
    s_lshl_b32 s54, s49, 10
    s_add_u32 s28, s10, s54
    s_addc_u32 s29, s11, 0
    s_mov_b32 s30, 0x37e400
    s_mov_b32 s31, 0x00020000
    s_mul_i32 s54, s51, 14336
    s_add_u32 s32, s4, s54
    s_addc_u32 s33, s5, 0
    s_mov_b32 s34, 0x3800
    s_mov_b32 s35, 0x00020000
    s_mov_b32 s36, s18
    s_mov_b32 s37, s19
    s_mov_b32 s38, 0x10000000
    s_mov_b32 s39, 0x00020000
    s_mov_b32 s44, s14
    s_mov_b32 s45, s15
    s_mov_b32 s46, 0x1c000
    s_mov_b32 s47, 0x00020000
    s_lshl_b32 s54, s49, 10
    s_lshl_b32 s55, s50, 8
    s_add_u32 s54, s54, s55
    s_add_u32 s28, s10, s54
    s_addc_u32 s29, s11, 0
    s_sub_u32 s30, 3670016, s54
    s_lshl_b32 s54, s49, 3
    s_add_u32 s54, s54, s48
    s_mul_i32 s54, s54, 57344
    s_add_u32 s55, s50, 2
    s_and_b32 s55, s55, 3
    s_lshl_b32 s55, s55, 8
    s_add_u32 s54, s54, s55
    s_add_u32 s40, s12, s54
    s_addc_u32 s41, s13, 0
    s_sub_u32 s42, 3670016, s54
    s_mov_b32 s43, 0x00020000
    s_lshl_b32 s54, s2, 2
    s_add_u32 s54, s54, s48
    s_mul_i32 s54, s54, 5120
    s_mov_b32 s92, s54
    v_mov_b32 v96, -1
    v_mov_b32 v97, -1
    v_mov_b32 v98, -1
    v_mov_b32 v99, -1
    v_lshlrev_b32 v26, 4, v0
    s_lshl_b32 s54, s48, 6
    buffer_load_dwordx4 a[0:3], v15, s[32:35], s54 offen
    s_lshl_b32 s54, s48, 6
    s_add_u32 s54, s54, 256
    buffer_load_dwordx4 a[4:7], v15, s[32:35], s54 offen
    s_lshl_b32 s54, s48, 6
    s_add_u32 s54, s54, 512
    buffer_load_dwordx4 a[8:11], v15, s[32:35], s54 offen
    s_lshl_b32 s54, s48, 6
    s_add_u32 s54, s54, 768
    s_cmp_ge_u32 s48, 2
    s_cselect_b32 s54, 0x40000000, s54
    buffer_load_dwordx4 a[12:15], v15, s[32:35], s54 offen
    s_mov_b32 s53, 0
    buffer_load_dwordx4 v[128:131], v14, s[28:31], s53 offen
    s_mov_b32 s53, 8192
    buffer_load_dwordx4 v[132:135], v14, s[28:31], s53 offen
    s_add_u32 m0, s52, 8192
    s_mov_b32 s53, 8192
    buffer_load_dwordx4 v1, s[20:23], s53 offen nt lds
    s_mov_b32 s53, 16384
    buffer_load_dwordx4 v[136:139], v14, s[28:31], s53 offen
    s_mov_b32 s53, 24576
    buffer_load_dwordx4 v[140:143], v14, s[28:31], s53 offen
    s_add_u32 m0, s52, 9216
    s_mov_b32 s53, 9216
    buffer_load_dwordx4 v2, s[20:23], s53 offen nt lds
    s_mov_b32 s53, 32768
    buffer_load_dwordx4 v[144:147], v14, s[28:31], s53 offen
    s_mov_b32 s53, 40960
    buffer_load_dwordx4 v[148:151], v14, s[28:31], s53 offen
    s_add_u32 m0, s52, 10240
    s_mov_b32 s53, 10240
    buffer_load_dwordx4 v3, s[20:23], s53 offen nt lds
    s_mov_b32 s53, 49152
    buffer_load_dwordx4 v[152:155], v14, s[28:31], s53 offen
    s_mov_b32 s53, 57344
    buffer_load_dwordx4 v[156:159], v14, s[28:31], s53 offen
    s_add_u32 m0, s52, 11264
    s_mov_b32 s53, 11264
    buffer_load_dwordx4 v4, s[20:23], s53 offen nt lds
    s_mov_b32 s53, 1048576
    buffer_load_dwordx4 v[160:163], v14, s[28:31], s53 offen
    s_mov_b32 s53, 1056768
    buffer_load_dwordx4 v[164:167], v14, s[28:31], s53 offen
    s_add_u32 m0, s52, 12288
    s_mov_b32 s53, 12288
    buffer_load_dwordx4 v5, s[20:23], s53 offen nt lds
    s_mov_b32 s53, 1064960
    buffer_load_dwordx4 v[168:171], v14, s[28:31], s53 offen
    s_mov_b32 s53, 1073152
    buffer_load_dwordx4 v[172:175], v14, s[28:31], s53 offen
    s_add_u32 m0, s52, 13312
    s_mov_b32 s53, 13312
    buffer_load_dwordx4 v6, s[20:23], s53 offen nt lds
    s_mov_b32 s53, 1081344
    buffer_load_dwordx4 v[176:179], v14, s[28:31], s53 offen
    s_mov_b32 s53, 1089536
    buffer_load_dwordx4 v[180:183], v14, s[28:31], s53 offen
    s_add_u32 m0, s52, 14336
    s_mov_b32 s53, 14336
    buffer_load_dwordx4 v7, s[20:23], s53 offen nt lds
    s_mov_b32 s53, 1097728
    buffer_load_dwordx4 v[184:187], v14, s[28:31], s53 offen
    s_mov_b32 s53, 1105920
    buffer_load_dwordx4 v[188:191], v14, s[28:31], s53 offen
    s_add_u32 m0, s52, 15360
    s_mov_b32 s53, 15360
    buffer_load_dwordx4 v8, s[20:23], s53 offen nt lds
    s_mov_b32 s53, 2097152
    buffer_load_dwordx4 v[192:195], v14, s[28:31], s53 offen
    s_mov_b32 s53, 2105344
    buffer_load_dwordx4 v[196:199], v14, s[28:31], s53 offen
    s_add_u32 m0, s52, 16384
    s_mov_b32 s53, 16384
    buffer_load_dwordx4 v1, s[20:23], s53 offen nt lds
    s_mov_b32 s53, 2113536
    buffer_load_dwordx4 v[200:203], v14, s[28:31], s53 offen
    s_mov_b32 s53, 2121728
    buffer_load_dwordx4 v[204:207], v14, s[28:31], s53 offen
    s_add_u32 m0, s52, 17408
    s_mov_b32 s53, 17408
    buffer_load_dwordx4 v2, s[20:23], s53 offen nt lds
    s_mov_b32 s53, 2129920
    buffer_load_dwordx4 v[208:211], v14, s[28:31], s53 offen
    s_mov_b32 s53, 2138112
    buffer_load_dwordx4 v[212:215], v14, s[28:31], s53 offen
    s_add_u32 m0, s52, 18432
    s_mov_b32 s53, 18432
    buffer_load_dwordx4 v3, s[20:23], s53 offen nt lds
    s_mov_b32 s53, 2146304
    buffer_load_dwordx4 v[216:219], v14, s[28:31], s53 offen
    s_mov_b32 s53, 2154496
    buffer_load_dwordx4 v[220:223], v14, s[28:31], s53 offen
    s_add_u32 m0, s52, 19456
    s_mov_b32 s53, 19456
    buffer_load_dwordx4 v4, s[20:23], s53 offen nt lds
    s_mov_b32 s53, 3145728
    buffer_load_dwordx4 v[224:227], v14, s[28:31], s53 offen
    s_mov_b32 s53, 3153920
    buffer_load_dwordx4 v[228:231], v14, s[28:31], s53 offen
    s_add_u32 m0, s52, 20480
    s_mov_b32 s53, 20480
    buffer_load_dwordx4 v5, s[20:23], s53 offen nt lds
    s_mov_b32 s53, 3162112
    buffer_load_dwordx4 v[232:235], v14, s[28:31], s53 offen
    s_mov_b32 s53, 3170304
    buffer_load_dwordx4 v[236:239], v14, s[28:31], s53 offen
    s_add_u32 m0, s52, 21504
    s_mov_b32 s53, 21504
    buffer_load_dwordx4 v6, s[20:23], s53 offen nt lds
    s_mov_b32 s53, 3178496
    buffer_load_dwordx4 v[240:243], v14, s[28:31], s53 offen
    s_mov_b32 s53, 3186688
    buffer_load_dwordx4 v[244:247], v14, s[28:31], s53 offen
    s_add_u32 m0, s52, 22528
    s_mov_b32 s53, 22528
    buffer_load_dwordx4 v7, s[20:23], s53 offen nt lds
    s_mov_b32 s53, 3194880
    buffer_load_dwordx4 v[248:251], v14, s[28:31], s53 offen
    s_mov_b32 s53, 3203072
    buffer_load_dwordx4 v[252:255], v14, s[28:31], s53 offen
    s_add_u32 m0, s52, 23552
    s_mov_b32 s53, 23552
    buffer_load_dwordx4 v8, s[20:23], s53 offen nt lds
    s_waitcnt lgkmcnt(0)
    s_add_u32 s58, s63, 0x9e3779b9
    s_add_u32 s59, s58, 0x7f4a7c15
    s_waitcnt vmcnt(37)
    v_perm_b32 v64, v132, v128, s60
    v_perm_b32 v65, v140, v136, s60
    v_perm_b32 v66, v148, v144, s60
    v_perm_b32 v67, v156, v152, s60
    v_perm_b32 v68, v132, v128, s61
    v_perm_b32 v69, v140, v136, s61
    v_perm_b32 v70, v148, v144, s61
    v_perm_b32 v71, v156, v152, s61
    s_add_u32 m0, s52, 24576
    s_mov_b32 s53, 24576
    buffer_load_dwordx4 v1, s[20:23], s53 offen nt lds
    v_perm_b32 v72, v133, v129, s60
    v_perm_b32 v73, v141, v137, s60
    v_perm_b32 v74, v149, v145, s60
    v_perm_b32 v75, v157, v153, s60
    v_perm_b32 v76, v133, v129, s61
    v_perm_b32 v77, v141, v137, s61
    v_perm_b32 v78, v149, v145, s61
    v_perm_b32 v79, v157, v153, s61
    v_mfma_f32_16x16x32_bf16 v[32:35], v[64:67], a[0:3], 0
    v_mfma_f32_16x16x32_bf16 v[36:39], v[68:71], a[0:3], 0
    s_add_u32 m0, s52, 25600
    s_mov_b32 s53, 25600
    buffer_load_dwordx4 v2, s[20:23], s53 offen nt lds
    v_perm_b32 v64, v134, v130, s60
    v_perm_b32 v65, v142, v138, s60
    v_perm_b32 v66, v150, v146, s60
    v_perm_b32 v67, v158, v154, s60
    v_perm_b32 v68, v134, v130, s61
    v_perm_b32 v69, v142, v138, s61
    v_perm_b32 v70, v150, v146, s61
    v_perm_b32 v71, v158, v154, s61
    v_mfma_f32_16x16x32_bf16 v[40:43], v[72:75], a[0:3], 0
    v_mfma_f32_16x16x32_bf16 v[44:47], v[76:79], a[0:3], 0
    s_add_u32 m0, s52, 26624
    s_mov_b32 s53, 26624
    buffer_load_dwordx4 v3, s[20:23], s53 offen nt lds
    v_perm_b32 v72, v135, v131, s60
    v_perm_b32 v73, v143, v139, s60
    v_perm_b32 v74, v151, v147, s60
    v_perm_b32 v75, v159, v155, s60
    v_perm_b32 v76, v135, v131, s61
    v_perm_b32 v77, v143, v139, s61
    v_perm_b32 v78, v151, v147, s61
    v_perm_b32 v79, v159, v155, s61
    v_mfma_f32_16x16x32_bf16 v[48:51], v[64:67], a[0:3], 0
    v_mfma_f32_16x16x32_bf16 v[52:55], v[68:71], a[0:3], 0
    s_add_u32 m0, s52, 27648
    s_mov_b32 s53, 27648
    buffer_load_dwordx4 v4, s[20:23], s53 offen nt lds
    v_mfma_f32_16x16x32_bf16 v[56:59], v[72:75], a[0:3], 0
    v_mfma_f32_16x16x32_bf16 v[60:63], v[76:79], a[0:3], 0
    s_waitcnt vmcnt(29)
    v_perm_b32 v64, v164, v160, s60
    v_perm_b32 v65, v172, v168, s60
    v_perm_b32 v66, v180, v176, s60
    v_perm_b32 v67, v188, v184, s60
    v_perm_b32 v68, v164, v160, s61
    v_perm_b32 v69, v172, v168, s61
    v_perm_b32 v70, v180, v176, s61
    v_perm_b32 v71, v188, v184, s61
    s_add_u32 m0, s52, 28672
    s_mov_b32 s53, 28672
    buffer_load_dwordx4 v5, s[20:23], s53 offen nt lds
    v_perm_b32 v72, v165, v161, s60
    v_perm_b32 v73, v173, v169, s60
    v_perm_b32 v74, v181, v177, s60
    v_perm_b32 v75, v189, v185, s60
    v_perm_b32 v76, v165, v161, s61
    v_perm_b32 v77, v173, v169, s61
    v_perm_b32 v78, v181, v177, s61
    v_perm_b32 v79, v189, v185, s61
    v_mfma_f32_16x16x32_bf16 v[32:35], v[64:67], a[4:7], v[32:35]
    v_mfma_f32_16x16x32_bf16 v[36:39], v[68:71], a[4:7], v[36:39]
    s_add_u32 m0, s52, 29696
    s_mov_b32 s53, 29696
    buffer_load_dwordx4 v6, s[20:23], s53 offen nt lds
    v_perm_b32 v64, v166, v162, s60
    v_perm_b32 v65, v174, v170, s60
    v_perm_b32 v66, v182, v178, s60
    v_perm_b32 v67, v190, v186, s60
    v_perm_b32 v68, v166, v162, s61
    v_perm_b32 v69, v174, v170, s61
    v_perm_b32 v70, v182, v178, s61
    v_perm_b32 v71, v190, v186, s61
    v_mfma_f32_16x16x32_bf16 v[40:43], v[72:75], a[4:7], v[40:43]
    v_mfma_f32_16x16x32_bf16 v[44:47], v[76:79], a[4:7], v[44:47]
    v_perm_b32 v72, v167, v163, s60
    v_perm_b32 v73, v175, v171, s60
    v_perm_b32 v74, v183, v179, s60
    v_perm_b32 v75, v191, v187, s60
    v_perm_b32 v76, v167, v163, s61
    v_perm_b32 v77, v175, v171, s61
    v_perm_b32 v78, v183, v179, s61
    v_perm_b32 v79, v191, v187, s61
    v_mfma_f32_16x16x32_bf16 v[48:51], v[64:67], a[4:7], v[48:51]
    v_mfma_f32_16x16x32_bf16 v[52:55], v[68:71], a[4:7], v[52:55]
    v_mfma_f32_16x16x32_bf16 v[56:59], v[72:75], a[4:7], v[56:59]
    v_mfma_f32_16x16x32_bf16 v[60:63], v[76:79], a[4:7], v[60:63]
    s_waitcnt vmcnt(19)
    v_perm_b32 v64, v196, v192, s60
    v_perm_b32 v65, v204, v200, s60
    v_perm_b32 v66, v212, v208, s60
    v_perm_b32 v67, v220, v216, s60
    v_perm_b32 v68, v196, v192, s61
    v_perm_b32 v69, v204, v200, s61
    v_perm_b32 v70, v212, v208, s61
    v_perm_b32 v71, v220, v216, s61
    v_perm_b32 v72, v197, v193, s60
    v_perm_b32 v73, v205, v201, s60
    v_perm_b32 v74, v213, v209, s60
    v_perm_b32 v75, v221, v217, s60
    v_perm_b32 v76, v197, v193, s61
    v_perm_b32 v77, v205, v201, s61
    v_perm_b32 v78, v213, v209, s61
    v_perm_b32 v79, v221, v217, s61
    v_mfma_f32_16x16x32_bf16 v[32:35], v[64:67], a[8:11], v[32:35]
    v_mfma_f32_16x16x32_bf16 v[36:39], v[68:71], a[8:11], v[36:39]
    v_perm_b32 v64, v198, v194, s60
    v_perm_b32 v65, v206, v202, s60
    v_perm_b32 v66, v214, v210, s60
    v_perm_b32 v67, v222, v218, s60
    v_perm_b32 v68, v198, v194, s61
    v_perm_b32 v69, v206, v202, s61
    v_perm_b32 v70, v214, v210, s61
    v_perm_b32 v71, v222, v218, s61
    v_mfma_f32_16x16x32_bf16 v[40:43], v[72:75], a[8:11], v[40:43]
    v_mfma_f32_16x16x32_bf16 v[44:47], v[76:79], a[8:11], v[44:47]
    v_perm_b32 v72, v199, v195, s60
    v_perm_b32 v73, v207, v203, s60
    v_perm_b32 v74, v215, v211, s60
    v_perm_b32 v75, v223, v219, s60
    v_perm_b32 v76, v199, v195, s61
    v_perm_b32 v77, v207, v203, s61
    v_perm_b32 v78, v215, v211, s61
    v_perm_b32 v79, v223, v219, s61
    v_mfma_f32_16x16x32_bf16 v[48:51], v[64:67], a[8:11], v[48:51]
    v_mfma_f32_16x16x32_bf16 v[52:55], v[68:71], a[8:11], v[52:55]
    v_mfma_f32_16x16x32_bf16 v[56:59], v[72:75], a[8:11], v[56:59]
    v_mfma_f32_16x16x32_bf16 v[60:63], v[76:79], a[8:11], v[60:63]
    s_waitcnt vmcnt(7)
    v_perm_b32 v64, v228, v224, s60
    v_perm_b32 v65, v236, v232, s60
    v_perm_b32 v66, v244, v240, s60
    v_perm_b32 v67, v252, v248, s60
    v_perm_b32 v68, v228, v224, s61
    v_perm_b32 v69, v236, v232, s61
    v_perm_b32 v70, v244, v240, s61
    v_perm_b32 v71, v252, v248, s61
    v_perm_b32 v72, v229, v225, s60
    v_perm_b32 v73, v237, v233, s60
    v_perm_b32 v74, v245, v241, s60
    v_perm_b32 v75, v253, v249, s60
    v_perm_b32 v76, v229, v225, s61
    v_perm_b32 v77, v237, v233, s61
    v_perm_b32 v78, v245, v241, s61
    v_perm_b32 v79, v253, v249, s61
    v_mfma_f32_16x16x32_bf16 v[32:35], v[64:67], a[12:15], v[32:35]
    v_mfma_f32_16x16x32_bf16 v[36:39], v[68:71], a[12:15], v[36:39]
    v_perm_b32 v64, v230, v226, s60
    v_perm_b32 v65, v238, v234, s60
    v_perm_b32 v66, v246, v242, s60
    v_perm_b32 v67, v254, v250, s60
    v_perm_b32 v68, v230, v226, s61
    v_perm_b32 v69, v238, v234, s61
    v_perm_b32 v70, v246, v242, s61
    v_perm_b32 v71, v254, v250, s61
    v_mfma_f32_16x16x32_bf16 v[40:43], v[72:75], a[12:15], v[40:43]
    v_mfma_f32_16x16x32_bf16 v[44:47], v[76:79], a[12:15], v[44:47]
    v_perm_b32 v72, v231, v227, s60
    v_perm_b32 v73, v239, v235, s60
    v_perm_b32 v74, v247, v243, s60
    v_perm_b32 v75, v255, v251, s60
    v_perm_b32 v76, v231, v227, s61
    v_perm_b32 v77, v239, v235, s61
    v_perm_b32 v78, v247, v243, s61
    v_perm_b32 v79, v255, v251, s61
    v_mfma_f32_16x16x32_bf16 v[48:51], v[64:67], a[12:15], v[48:51]
    v_mfma_f32_16x16x32_bf16 v[52:55], v[68:71], a[12:15], v[52:55]
    v_mfma_f32_16x16x32_bf16 v[56:59], v[72:75], a[12:15], v[56:59]
    v_mfma_f32_16x16x32_bf16 v[60:63], v[76:79], a[12:15], v[60:63]
    s_lshl_b32 s54, s48, 13
    s_add_u32 s54, s54, 122880
    v_add_u32 v27, s54, v26
    s_nop 5
    ds_write_b128 v27, v[32:35] offset:0
    ds_write_b128 v27, v[36:39] offset:1024
    ds_write_b128 v27, v[40:43] offset:2048
    ds_write_b128 v27, v[44:47] offset:3072
    ds_write_b128 v27, v[48:51] offset:4096
    ds_write_b128 v27, v[52:55] offset:5120
    ds_write_b128 v27, v[56:59] offset:6144
    ds_write_b128 v27, v[60:63] offset:7168
    s_waitcnt lgkmcnt(0)
    s_barrier
    s_lshl_b32 s54, s48, 11
    s_add_u32 s54, s54, 122880
    v_add_u32 v27, s54, v26
    ds_read_b128 v[32:35], v27 offset:0
    ds_read_b128 v[36:39], v27 offset:8192
    ds_read_b128 v[40:43], v27 offset:16384
    ds_read_b128 v[44:47], v27 offset:24576
    ds_read_b128 v[48:51], v27 offset:1024
    ds_read_b128 v[52:55], v27 offset:9216
    ds_read_b128 v[56:59], v27 offset:17408
    ds_read_b128 v[60:63], v27 offset:25600
    s_waitcnt lgkmcnt(4)
    v_add_f32 v32, v32, v36
    v_add_f32 v40, v40, v44
    v_add_f32 v33, v33, v37
    v_add_f32 v41, v41, v45
    v_add_f32 v34, v34, v38
    v_add_f32 v42, v42, v46
    v_add_f32 v35, v35, v39
    v_add_f32 v43, v43, v47
    v_add_f32 v32, v32, v40
    v_add_f32 v33, v33, v41
    v_add_f32 v34, v34, v42
    v_add_f32 v35, v35, v43
    s_waitcnt lgkmcnt(0)
    v_add_f32 v48, v48, v52
    v_add_f32 v56, v56, v60
    v_add_f32 v49, v49, v53
    v_add_f32 v57, v57, v61
    v_add_f32 v50, v50, v54
    v_add_f32 v58, v58, v62
    v_add_f32 v51, v51, v55
    v_add_f32 v59, v59, v63
    v_add_f32 v48, v48, v56
    v_add_f32 v49, v49, v57
    v_add_f32 v50, v50, v58
    v_add_f32 v51, v51, v59
    s_barrier
    v_cvt_pk_bf16_f32 v64, v32, v48
    v_cvt_pk_bf16_f32 v66, v33, v49
    v_cvt_pk_bf16_f32 v68, v34, v50
    v_cvt_pk_bf16_f32 v70, v35, v51
    v_mov_b32 v65, s58
    v_mov_b32 v67, s59
    v_mov_b32 v69, s58
    v_mov_b32 v71, s59
    s_lshl_b32 s54, s2, 2
    s_add_u32 s54, s54, s48
    s_lshl_b32 s54, s54, 11
    s_add_u32 s54, s54, 0x600000
    buffer_store_dwordx4 v[64:67], v26, s[36:39], s54 offen offset:0 sc1
    buffer_store_dwordx4 v[68:71], v26, s[36:39], s54 offen offset:1024 sc1
    v_add_u32 v26, 0, v17
    v_cmp_le_u32 vcc, 30, v26
    v_subrev_u32 v27, 30, v26
    s_nop 0
    v_cndmask_b32 v26, v26, v27, vcc
    v_lshl_add_u32 v18, v26, 10, v16
    v_xor_b32 v19, 32, v18
    v_xor_b32 v20, 64, v18
    v_xor_b32 v21, 96, v18
    v_xor_b32 v22, 128, v18
    v_xor_b32 v23, 160, v18
    v_xor_b32 v24, 192, v18
    v_xor_b32 v25, 224, v18
    ds_read_b128 a[128:131], v18 offset:0
    ds_read_b128 a[132:135], v19 offset:0
    ds_read_b128 a[136:139], v20 offset:0
    ds_read_b128 a[140:143], v21 offset:0
    ds_read_b128 a[144:147], v22 offset:0
    ds_read_b128 a[148:151], v23 offset:0
    ds_read_b128 a[152:155], v24 offset:0
    ds_read_b128 a[156:159], v25 offset:0
    ds_read_b128 a[160:163], v18 offset:256
    ds_read_b128 a[164:167], v19 offset:256
    ds_read_b128 a[168:171], v20 offset:256
    ds_read_b128 a[172:175], v21 offset:256
    s_waitcnt lgkmcnt(8)
    ds_read_b128 a[176:179], v22 offset:256
    ds_read_b128 a[180:183], v23 offset:256
    ds_read_b128 a[184:187], v24 offset:256
    ds_read_b128 a[188:191], v25 offset:256
    s_waitcnt lgkmcnt(0)
    v_lshrrev_b32 v28, 4, v0
    v_and_b32 v29, 1, v28
    v_lshlrev_b32 v29, 8, v29
    v_lshrrev_b32 v28, 1, v28
    v_lshl_add_u32 v29, v28, 2, v29
    v_mul_u32_u24 v29, 896, v29
    v_and_b32 v28, 15, v0
    v_lshl_add_u32 v14, v28, 4, v29
    s_cmp_eq_u32 s50, 1
    s_cselect_b32 s54, 8, 16
    v_cmp_le_u32 vcc, s54, v28
    v_mov_b32 v29, 0x40000000
    s_nop 1
    v_cndmask_b32 v14, v14, v29, vcc
    s_add_u32 m0, s52, 0
    s_mov_b32 s53, 30720
    buffer_load_dwordx4 v7, s[20:23], s53 offen nt lds
    s_add_u32 m0, s52, 1024
    s_mov_b32 s53, 31744
    buffer_load_dwordx4 v8, s[20:23], s53 offen nt lds
    s_mov_b32 s53, 0
    buffer_load_dwordx4 v[128:131], v14, s[40:43], s53 offen
    s_add_u32 m0, s52, 2048
    s_mov_b32 s53, 32768
    buffer_load_dwordx4 v1, s[20:23], s53 offen nt lds
    s_add_u32 m0, s52, 3072
    s_mov_b32 s53, 33792
    buffer_load_dwordx4 v2, s[20:23], s53 offen nt lds
    s_mov_b32 s53, 896
    buffer_load_dwordx4 v[132:135], v14, s[40:43], s53 offen
    s_add_u32 m0, s52, 4096
    s_mov_b32 s53, 34816
    buffer_load_dwordx4 v3, s[20:23], s53 offen nt lds
    s_add_u32 m0, s52, 5120
    s_mov_b32 s53, 35840
    buffer_load_dwordx4 v4, s[20:23], s53 offen nt lds
    s_mov_b32 s53, 1792
    buffer_load_dwordx4 v[136:139], v14, s[40:43], s53 offen
    s_add_u32 m0, s52, 6144
    s_mov_b32 s53, 36864
    buffer_load_dwordx4 v5, s[20:23], s53 offen nt lds
    s_add_u32 m0, s52, 7168
    s_mov_b32 s53, 37888
    buffer_load_dwordx4 v6, s[20:23], s53 offen nt lds
    s_mov_b32 s53, 2688
    buffer_load_dwordx4 v[140:143], v14, s[40:43], s53 offen
    s_add_u32 m0, s52, 8192
    s_mov_b32 s53, 38912
    buffer_load_dwordx4 v7, s[20:23], s53 offen nt lds
    s_add_u32 m0, s52, 9216
    s_mov_b32 s53, 39936
    buffer_load_dwordx4 v8, s[20:23], s53 offen nt lds
    s_mov_b32 s53, 7168
    buffer_load_dwordx4 v[144:147], v14, s[40:43], s53 offen
    s_add_u32 m0, s52, 10240
    s_mov_b32 s53, 40960
    buffer_load_dwordx4 v1, s[20:23], s53 offen nt lds
    s_add_u32 m0, s52, 11264
    s_mov_b32 s53, 41984
    buffer_load_dwordx4 v2, s[20:23], s53 offen nt lds
    s_mov_b32 s53, 8064
    buffer_load_dwordx4 v[148:151], v14, s[40:43], s53 offen
    s_add_u32 m0, s52, 12288
    s_mov_b32 s53, 43008
    buffer_load_dwordx4 v3, s[20:23], s53 offen nt lds
    s_add_u32 m0, s52, 13312
    s_mov_b32 s53, 44032
    buffer_load_dwordx4 v4, s[20:23], s53 offen nt lds
    s_mov_b32 s53, 8960
    buffer_load_dwordx4 v[152:155], v14, s[40:43], s53 offen
    s_add_u32 m0, s52, 14336
    s_mov_b32 s53, 45056
    buffer_load_dwordx4 v5, s[20:23], s53 offen nt lds
    s_add_u32 m0, s52, 15360
    s_mov_b32 s53, 46080
    buffer_load_dwordx4 v6, s[20:23], s53 offen nt lds
    s_mov_b32 s53, 9856
    buffer_load_dwordx4 v[156:159], v14, s[40:43], s53 offen
    s_lshl_b32 s54, s51, 5
    s_add_u32 s54, s54, s49
    s_lshl_b32 s54, s54, 2
    s_add_u32 s54, s54, s48
    s_lshl_b32 s54, s54, 11
    s_add_u32 s54, s54, 0x600000
    v_lshlrev_b32 v26, 4, v0
    buffer_load_dwordx4 v[96:99], v26, s[36:39], s54 offen offset:0 sc1
    buffer_load_dwordx4 v[100:103], v26, s[36:39], s54 offen offset:1024 sc1
    s_add_u32 s54, s54, 65536
    buffer_load_dwordx4 v[104:107], v26, s[36:39], s54 offen offset:0 sc1
    buffer_load_dwordx4 v[108:111], v26, s[36:39], s54 offen offset:1024 sc1
    s_add_u32 s54, s54, 65536
    buffer_load_dwordx4 v[112:115], v26, s[36:39], s54 offen offset:0 sc1
    buffer_load_dwordx4 v[116:119], v26, s[36:39], s54 offen offset:1024 sc1
    s_add_u32 s54, s54, 65536
    buffer_load_dwordx4 v[120:123], v26, s[36:39], s54 offen offset:0 sc1
    buffer_load_dwordx4 v[124:127], v26, s[36:39], s54 offen offset:1024 sc1
    v_add_u32 v26, 16, v17
    v_cmp_le_u32 vcc, 30, v26
    v_subrev_u32 v27, 30, v26
    s_nop 0
    v_cndmask_b32 v26, v26, v27, vcc
    v_lshl_add_u32 v18, v26, 10, v16
    v_xor_b32 v19, 32, v18
    v_xor_b32 v20, 64, v18
    v_xor_b32 v21, 96, v18
    v_xor_b32 v22, 128, v18
    v_xor_b32 v23, 160, v18
    v_xor_b32 v24, 192, v18
    v_xor_b32 v25, 224, v18
    s_waitcnt vmcnt(30)
    ds_read_b128 a[192:195], v18 offset:0
    ds_read_b128 a[196:199], v19 offset:0
    ds_read_b128 a[200:203], v20 offset:0
    ds_read_b128 a[204:207], v21 offset:0
    ds_read_b128 a[208:211], v22 offset:0
    ds_read_b128 a[212:215], v23 offset:0
    ds_read_b128 a[216:219], v24 offset:0
    ds_read_b128 a[220:223], v25 offset:0
    ds_read_b128 a[224:227], v18 offset:256
    ds_read_b128 a[228:231], v19 offset:256
    ds_read_b128 a[232:235], v20 offset:256
    ds_read_b128 a[236:239], v21 offset:256
    s_waitcnt lgkmcnt(8)
    ds_read_b128 a[240:243], v22 offset:256
    ds_read_b128 a[244:247], v23 offset:256
    ds_read_b128 a[248:251], v24 offset:256
    ds_read_b128 a[252:255], v25 offset:256
    s_waitcnt lgkmcnt(0)
    s_add_u32 m0, s52, 16384
    s_mov_b32 s53, 47104
    buffer_load_dwordx4 v7, s[20:23], s53 offen nt lds
    s_add_u32 m0, s52, 17408
    s_mov_b32 s53, 48128
    buffer_load_dwordx4 v8, s[20:23], s53 offen nt lds
    s_mov_b32 s53, 14336
    buffer_load_dwordx4 v[160:163], v14, s[40:43], s53 offen
    s_add_u32 m0, s52, 18432
    s_mov_b32 s53, 49152
    buffer_load_dwordx4 v1, s[20:23], s53 offen nt lds
    s_add_u32 m0, s52, 19456
    s_mov_b32 s53, 50176
    buffer_load_dwordx4 v2, s[20:23], s53 offen nt lds
    s_mov_b32 s53, 15232
    buffer_load_dwordx4 v[164:167], v14, s[40:43], s53 offen
    s_add_u32 m0, s52, 20480
    s_mov_b32 s53, 51200
    buffer_load_dwordx4 v3, s[20:23], s53 offen nt lds
    s_add_u32 m0, s52, 21504
    s_mov_b32 s53, 52224
    buffer_load_dwordx4 v4, s[20:23], s53 offen nt lds
    s_mov_b32 s53, 16128
    buffer_load_dwordx4 v[168:171], v14, s[40:43], s53 offen
    s_add_u32 m0, s52, 22528
    s_mov_b32 s53, 53248
    buffer_load_dwordx4 v5, s[20:23], s53 offen nt lds
    s_add_u32 m0, s52, 23552
    s_mov_b32 s53, 54272
    buffer_load_dwordx4 v6, s[20:23], s53 offen nt lds
    s_mov_b32 s53, 17024
    buffer_load_dwordx4 v[172:175], v14, s[40:43], s53 offen
    s_add_u32 m0, s52, 24576
    s_mov_b32 s53, 55296
    buffer_load_dwordx4 v7, s[20:23], s53 offen nt lds
    s_add_u32 m0, s52, 25600
    s_mov_b32 s53, 56320
    buffer_load_dwordx4 v8, s[20:23], s53 offen nt lds
    s_mov_b32 s53, 21504
    buffer_load_dwordx4 v[176:179], v14, s[40:43], s53 offen
    s_add_u32 m0, s52, 26624
    s_mov_b32 s53, 57344
    buffer_load_dwordx4 v1, s[20:23], s53 offen nt lds
    s_add_u32 m0, s52, 27648
    s_mov_b32 s53, 58368
    buffer_load_dwordx4 v2, s[20:23], s53 offen nt lds
    s_mov_b32 s53, 22400
    buffer_load_dwordx4 v[180:183], v14, s[40:43], s53 offen
    s_add_u32 m0, s52, 28672
    s_mov_b32 s53, 59392
    buffer_load_dwordx4 v3, s[20:23], s53 offen nt lds
    s_add_u32 m0, s52, 29696
    s_mov_b32 s53, 60416
    buffer_load_dwordx4 v4, s[20:23], s53 offen nt lds
    s_mov_b32 s53, 23296
    buffer_load_dwordx4 v[184:187], v14, s[40:43], s53 offen
    s_add_u32 m0, s52, 0
    s_mov_b32 s53, 61440
    buffer_load_dwordx4 v5, s[20:23], s53 offen nt lds
    s_add_u32 m0, s52, 1024
    s_mov_b32 s53, 62464
    buffer_load_dwordx4 v6, s[20:23], s53 offen nt lds
    s_mov_b32 s53, 24192
    buffer_load_dwordx4 v[188:191], v14, s[40:43], s53 offen
    s_waitcnt vmcnt(24)
    v_xor_b32 v28, s58, v97
    v_xor_b32 v29, s59, v99
    v_or_b32 v27, v28, v29
    v_xor_b32 v28, s58, v101
    v_xor_b32 v29, s59, v103
    v_or3_b32 v27, v27, v28, v29
    v_xor_b32 v28, s58, v105
    v_xor_b32 v29, s59, v107
    v_or3_b32 v27, v27, v28, v29
    v_xor_b32 v28, s58, v109
    v_xor_b32 v29, s59, v111
    v_or3_b32 v27, v27, v28, v29
    v_xor_b32 v28, s58, v113
    v_xor_b32 v29, s59, v115
    v_or3_b32 v27, v27, v28, v29
    v_xor_b32 v28, s58, v117
    v_xor_b32 v29, s59, v119
    v_or3_b32 v27, v27, v28, v29
    v_xor_b32 v28, s58, v121
    v_xor_b32 v29, s59, v123
    v_or3_b32 v27, v27, v28, v29
    v_xor_b32 v28, s58, v125
    v_xor_b32 v29, s59, v127
    v_or3_b32 v27, v27, v28, v29
    v_cmp_ne_u32 vcc, 0, v27
    s_nop 3
    s_cbranch_vccz L_e0_ok
L_e0_retry:
    s_add_u32 s94, s94, 1
    s_cmp_ge_u32 s94, 0x40000
    s_cbranch_scc1 L_exitA
    s_lshl_b32 s54, s51, 5
    s_add_u32 s54, s54, s49
    s_lshl_b32 s54, s54, 2
    s_add_u32 s54, s54, s48
    s_lshl_b32 s54, s54, 11
    s_add_u32 s54, s54, 0x600000
    v_lshlrev_b32 v26, 4, v0
    buffer_load_dwordx4 v[96:99], v26, s[36:39], s54 offen offset:0 sc1
    buffer_load_dwordx4 v[100:103], v26, s[36:39], s54 offen offset:1024 sc1
    s_add_u32 s54, s54, 65536
    buffer_load_dwordx4 v[104:107], v26, s[36:39], s54 offen offset:0 sc1
    buffer_load_dwordx4 v[108:111], v26, s[36:39], s54 offen offset:1024 sc1
    s_add_u32 s54, s54, 65536
    buffer_load_dwordx4 v[112:115], v26, s[36:39], s54 offen offset:0 sc1
    buffer_load_dwordx4 v[116:119], v26, s[36:39], s54 offen offset:1024 sc1
    s_add_u32 s54, s54, 65536
    buffer_load_dwordx4 v[120:123], v26, s[36:39], s54 offen offset:0 sc1
    buffer_load_dwordx4 v[124:127], v26, s[36:39], s54 offen offset:1024 sc1
    s_waitcnt vmcnt(0)
    v_xor_b32 v28, s58, v97
    v_xor_b32 v29, s59, v99
    v_or_b32 v27, v28, v29
    v_xor_b32 v28, s58, v101
    v_xor_b32 v29, s59, v103
    v_or3_b32 v27, v27, v28, v29
    v_xor_b32 v28, s58, v105
    v_xor_b32 v29, s59, v107
    v_or3_b32 v27, v27, v28, v29
    v_xor_b32 v28, s58, v109
    v_xor_b32 v29, s59, v111
    v_or3_b32 v27, v27, v28, v29
    v_xor_b32 v28, s58, v113
    v_xor_b32 v29, s59, v115
    v_or3_b32 v27, v27, v28, v29
    v_xor_b32 v28, s58, v117
    v_xor_b32 v29, s59, v119
    v_or3_b32 v27, v27, v28, v29
    v_xor_b32 v28, s58, v121
    v_xor_b32 v29, s59, v123
    v_or3_b32 v27, v27, v28, v29
    v_xor_b32 v28, s58, v125
    v_xor_b32 v29, s59, v127
    v_or3_b32 v27, v27, v28, v29
    v_cmp_ne_u32 vcc, 0, v27
    s_nop 3
    s_cbranch_vccnz L_e0_retry
L_e0_ok:
    v_lshrrev_b32 v28, 4, v0
    v_and_b32 v29, 15, v0
    v_lshlrev_b32 v28, 11, v28
    v_lshl_add_u32 v28, v29, 4, v28
    s_lshl_b32 s54, s48, 2
    s_add_u32 s54, s54, 122880
    v_add_u32 v28, s54, v28
    ds_write_b32 v28, v96 offset:0
    ds_write_b32 v28, v98 offset:512
    ds_write_b32 v28, v100 offset:1024
    ds_write_b32 v28, v102 offset:1536
    ds_write_b32 v28, v104 offset:8192
    ds_write_b32 v28, v106 offset:8704
    ds_write_b32 v28, v108 offset:9216
    ds_write_b32 v28, v110 offset:9728
    ds_write_b32 v28, v112 offset:256
    ds_write_b32 v28, v114 offset:768
    ds_write_b32 v28, v116 offset:1280
    ds_write_b32 v28, v118 offset:1792
    s_waitcnt lgkmcnt(8)
    ds_write_b32 v28, v120 offset:8448
    ds_write_b32 v28, v122 offset:8960
    ds_write_b32 v28, v124 offset:9472
    ds_write_b32 v28, v126 offset:9984
    s_waitcnt lgkmcnt(8)
    s_waitcnt lgkmcnt(0)
    s_barrier
    ds_read_b128 a[64:67], v12 offset:0
    ds_read_b128 a[68:71], v12 offset:1024
    ds_read_b128 a[72:75], v12 offset:2048
    ds_read_b128 a[76:79], v12 offset:3072
    ds_read_b128 a[80:83], v12 offset:4096
    ds_read_b128 a[84:87], v12 offset:5120
    ds_read_b128 a[88:91], v12 offset:6144
    ds_read_b128 a[92:95], v12 offset:7168
    ds_read_b128 a[96:99], v12 offset:8192
    ds_read_b128 a[100:103], v12 offset:9216
    ds_read_b128 a[104:107], v12 offset:10240
    ds_read_b128 a[108:111], v12 offset:11264
    s_waitcnt lgkmcnt(8)
    ds_read_b128 a[112:115], v12 offset:12288
    ds_read_b128 a[116:119], v12 offset:13312
    ds_read_b128 a[120:123], v12 offset:14336
    ds_read_b128 a[124:127], v12 offset:15360
    v_add_u32 v26, 2, v17
    v_cmp_le_u32 vcc, 30, v26
    v_subrev_u32 v27, 30, v26
    s_nop 0
    v_cndmask_b32 v26, v26, v27, vcc
    v_lshl_add_u32 v18, v26, 10, v16
    v_xor_b32 v19, 32, v18
    v_xor_b32 v20, 64, v18
    v_xor_b32 v21, 96, v18
    v_xor_b32 v22, 128, v18
    v_xor_b32 v23, 160, v18
    v_xor_b32 v24, 192, v18
    v_xor_b32 v25, 224, v18
    s_waitcnt lgkmcnt(0)
    s_waitcnt vmcnt(22)
    ds_read_b128 v[96:99], v18 offset:0
    ds_read_b128 v[100:103], v19 offset:0
    ds_read_b128 v[104:107], v20 offset:0
    ds_read_b128 v[108:111], v21 offset:0
    ds_read_b128 v[112:115], v22 offset:0
    ds_read_b128 v[116:119], v23 offset:0
    ds_read_b128 v[120:123], v24 offset:0
    ds_read_b128 v[124:127], v25 offset:0
    s_waitcnt lgkmcnt(7)
    v_mfma_f32_32x32x16_bf16 v[64:79], v[96:99], a[64:67], 0
    ds_read_b128 v[96:99], v18 offset:256
    s_waitcnt lgkmcnt(7)
    v_mfma_f32_32x32x16_bf16 v[64:79], v[100:103], a[68:71], v[64:79]
    ds_read_b128 v[100:103], v19 offset:256
    s_waitcnt lgkmcnt(7)
    v_mfma_f32_32x32x16_bf16 v[64:79], v[104:107], a[72:75], v[64:79]
    ds_read_b128 v[104:107], v20 offset:256
    s_waitcnt lgkmcnt(7)
    v_mfma_f32_32x32x16_bf16 v[64:79], v[108:111], a[76:79], v[64:79]
    ds_read_b128 v[108:111], v21 offset:256
    s_waitcnt lgkmcnt(7)
    v_mfma_f32_32x32x16_bf16 v[64:79], v[112:115], a[80:83], v[64:79]
    ds_read_b128 v[112:115], v22 offset:256
    s_waitcnt lgkmcnt(7)
    v_mfma_f32_32x32x16_bf16 v[64:79], v[116:119], a[84:87], v[64:79]
    ds_read_b128 v[116:119], v23 offset:256
    s_waitcnt lgkmcnt(7)
    v_mfma_f32_32x32x16_bf16 v[64:79], v[120:123], a[88:91], v[64:79]
    ds_read_b128 v[120:123], v24 offset:256
    s_waitcnt lgkmcnt(7)
    v_mfma_f32_32x32x16_bf16 v[64:79], v[124:127], a[92:95], v[64:79]
    ds_read_b128 v[124:127], v25 offset:256
    s_waitcnt lgkmcnt(7)
    v_mfma_f32_32x32x16_bf16 v[64:79], v[96:99], a[96:99], v[64:79]
    s_waitcnt lgkmcnt(6)
    v_mfma_f32_32x32x16_bf16 v[64:79], v[100:103], a[100:103], v[64:79]
    s_waitcnt lgkmcnt(5)
    v_mfma_f32_32x32x16_bf16 v[64:79], v[104:107], a[104:107], v[64:79]
    s_waitcnt lgkmcnt(4)
    v_mfma_f32_32x32x16_bf16 v[64:79], v[108:111], a[108:111], v[64:79]
    s_waitcnt lgkmcnt(3)
    v_mfma_f32_32x32x16_bf16 v[64:79], v[112:115], a[112:115], v[64:79]
    s_waitcnt lgkmcnt(2)
    v_mfma_f32_32x32x16_bf16 v[64:79], v[116:119], a[116:119], v[64:79]
    s_waitcnt lgkmcnt(1)
    v_mfma_f32_32x32x16_bf16 v[64:79], v[120:123], a[120:123], v[64:79]
    s_waitcnt lgkmcnt(0)
    v_mfma_f32_32x32x16_bf16 v[64:79], v[124:127], a[124:127], v[64:79]
    s_add_u32 m0, s52, 2048
    s_mov_b32 s53, 63488
    buffer_load_dwordx4 v7, s[20:23], s53 offen nt lds
    v_mfma_f32_32x32x16_bf16 v[32:47], a[128:131], a[64:67], 0
    v_mfma_f32_32x32x16_bf16 v[32:47], a[132:135], a[68:71], v[32:47]
    s_add_u32 m0, s52, 3072
    s_mov_b32 s53, 64512
    buffer_load_dwordx4 v8, s[20:23], s53 offen nt lds
    v_mfma_f32_32x32x16_bf16 v[32:47], a[136:139], a[72:75], v[32:47]
    v_mfma_f32_32x32x16_bf16 v[32:47], a[140:143], a[76:79], v[32:47]
    s_mov_b32 s53, 28672
    buffer_load_dwordx4 v[192:195], v14, s[40:43], s53 offen
    s_add_u32 m0, s52, 4096
    s_mov_b32 s53, 0
    buffer_load_dwordx4 v9, s[24:27], s53 offen nt lds
    v_mfma_f32_32x32x16_bf16 v[32:47], a[144:147], a[80:83], v[32:47]
    v_mfma_f32_32x32x16_bf16 v[32:47], a[148:151], a[84:87], v[32:47]
    s_add_u32 m0, s52, 5120
    s_mov_b32 s53, 4096
    buffer_load_dwordx4 v9, s[24:27], s53 offen nt lds
    v_mfma_f32_32x32x16_bf16 v[32:47], a[152:155], a[88:91], v[32:47]
    v_mfma_f32_32x32x16_bf16 v[32:47], a[156:159], a[92:95], v[32:47]
    s_mov_b32 s53, 29568
    buffer_load_dwordx4 v[196:199], v14, s[40:43], s53 offen
    s_add_u32 m0, s52, 6144
    s_mov_b32 s53, 8192
    buffer_load_dwordx4 v9, s[24:27], s53 offen nt lds
    v_mfma_f32_32x32x16_bf16 v[32:47], a[160:163], a[96:99], v[32:47]
    v_mfma_f32_32x32x16_bf16 v[32:47], a[164:167], a[100:103], v[32:47]
    s_add_u32 m0, s52, 7168
    s_mov_b32 s53, 12288
    buffer_load_dwordx4 v9, s[24:27], s53 offen nt lds
    v_mfma_f32_32x32x16_bf16 v[32:47], a[168:171], a[104:107], v[32:47]
    v_mfma_f32_32x32x16_bf16 v[32:47], a[172:175], a[108:111], v[32:47]
    s_mov_b32 s53, 30464
    buffer_load_dwordx4 v[200:203], v14, s[40:43], s53 offen
    s_add_u32 m0, s52, 8192
    s_mov_b32 s53, 16384
    buffer_load_dwordx4 v9, s[24:27], s53 offen nt lds
    v_mfma_f32_32x32x16_bf16 v[32:47], a[176:179], a[112:115], v[32:47]
    v_mfma_f32_32x32x16_bf16 v[32:47], a[180:183], a[116:119], v[32:47]
    s_add_u32 m0, s52, 9216
    s_mov_b32 s53, 20480
    buffer_load_dwordx4 v9, s[24:27], s53 offen nt lds
    v_mfma_f32_32x32x16_bf16 v[32:47], a[184:187], a[120:123], v[32:47]
    v_mfma_f32_32x32x16_bf16 v[32:47], a[188:191], a[124:127], v[32:47]
    s_mov_b32 s53, 31360
    buffer_load_dwordx4 v[204:207], v14, s[40:43], s53 offen
    s_add_u32 m0, s52, 10240
    s_mov_b32 s53, 24576
    buffer_load_dwordx4 v9, s[24:27], s53 offen nt lds
    v_mfma_f32_32x32x16_bf16 v[48:63], a[192:195], a[64:67], 0
    v_mfma_f32_32x32x16_bf16 v[48:63], a[196:199], a[68:71], v[48:63]
    s_add_u32 m0, s52, 11264
    s_mov_b32 s53, 28672
    buffer_load_dwordx4 v9, s[24:27], s53 offen nt lds
    v_mfma_f32_32x32x16_bf16 v[48:63], a[200:203], a[72:75], v[48:63]
    v_mfma_f32_32x32x16_bf16 v[48:63], a[204:207], a[76:79], v[48:63]
    s_mov_b32 s53, 35840
    buffer_load_dwordx4 v[208:211], v14, s[40:43], s53 offen
    s_add_u32 m0, s52, 12288
    s_mov_b32 s53, 32768
    buffer_load_dwordx4 v9, s[24:27], s53 offen nt lds
    v_mfma_f32_32x32x16_bf16 v[48:63], a[208:211], a[80:83], v[48:63]
    v_mfma_f32_32x32x16_bf16 v[48:63], a[212:215], a[84:87], v[48:63]
    s_add_u32 m0, s52, 13312
    s_mov_b32 s53, 36864
    buffer_load_dwordx4 v9, s[24:27], s53 offen nt lds
    v_mfma_f32_32x32x16_bf16 v[48:63], a[216:219], a[88:91], v[48:63]
    v_mfma_f32_32x32x16_bf16 v[48:63], a[220:223], a[92:95], v[48:63]
    s_mov_b32 s53, 36736
    buffer_load_dwordx4 v[212:215], v14, s[40:43], s53 offen
    s_add_u32 m0, s52, 14336
    s_mov_b32 s53, 40960
    buffer_load_dwordx4 v9, s[24:27], s53 offen nt lds
    v_mfma_f32_32x32x16_bf16 v[48:63], a[224:227], a[96:99], v[48:63]
    v_mfma_f32_32x32x16_bf16 v[48:63], a[228:231], a[100:103], v[48:63]
    s_add_u32 m0, s52, 15360
    s_mov_b32 s53, 45056
    buffer_load_dwordx4 v9, s[24:27], s53 offen nt lds
    v_mfma_f32_32x32x16_bf16 v[48:63], a[232:235], a[104:107], v[48:63]
    v_mfma_f32_32x32x16_bf16 v[48:63], a[236:239], a[108:111], v[48:63]
    s_mov_b32 s53, 37632
    buffer_load_dwordx4 v[216:219], v14, s[40:43], s53 offen
    s_add_u32 m0, s52, 16384
    s_mov_b32 s53, 49152
    buffer_load_dwordx4 v9, s[24:27], s53 offen nt lds
    v_mfma_f32_32x32x16_bf16 v[48:63], a[240:243], a[112:115], v[48:63]
    v_mfma_f32_32x32x16_bf16 v[48:63], a[244:247], a[116:119], v[48:63]
    s_add_u32 m0, s52, 17408
    s_mov_b32 s53, 53248
    buffer_load_dwordx4 v9, s[24:27], s53 offen nt lds
    v_mfma_f32_32x32x16_bf16 v[48:63], a[248:251], a[120:123], v[48:63]
    v_mfma_f32_32x32x16_bf16 v[48:63], a[252:255], a[124:127], v[48:63]
    s_mov_b32 s53, 38528
    buffer_load_dwordx4 v[220:223], v14, s[40:43], s53 offen
    v_add_u32 v26, 18, v17
    v_cmp_le_u32 vcc, 30, v26
    v_subrev_u32 v27, 30, v26
    s_nop 0
    v_cndmask_b32 v26, v26, v27, vcc
    v_lshl_add_u32 v18, v26, 10, v16
    v_xor_b32 v19, 32, v18
    v_xor_b32 v20, 64, v18
    v_xor_b32 v21, 96, v18
    v_xor_b32 v22, 128, v18
    v_xor_b32 v23, 160, v18
    v_xor_b32 v24, 192, v18
    v_xor_b32 v25, 224, v18
    s_waitcnt vmcnt(22)
    ds_read_b128 v[96:99], v18 offset:0
    ds_read_b128 v[100:103], v19 offset:0
    ds_read_b128 v[104:107], v20 offset:0
    ds_read_b128 v[108:111], v21 offset:0
    ds_read_b128 v[112:115], v22 offset:0
    ds_read_b128 v[116:119], v23 offset:0
    ds_read_b128 v[120:123], v24 offset:0
    ds_read_b128 v[124:127], v25 offset:0
    s_waitcnt lgkmcnt(7)
    v_mfma_f32_32x32x16_bf16 v[80:95], v[96:99], a[64:67], 0
    ds_read_b128 v[96:99], v18 offset:256
    s_waitcnt lgkmcnt(7)
    v_mfma_f32_32x32x16_bf16 v[80:95], v[100:103], a[68:71], v[80:95]
    ds_read_b128 v[100:103], v19 offset:256
    s_waitcnt lgkmcnt(7)
    v_mfma_f32_32x32x16_bf16 v[80:95], v[104:107], a[72:75], v[80:95]
    ds_read_b128 v[104:107], v20 offset:256
    s_waitcnt lgkmcnt(7)
    v_mfma_f32_32x32x16_bf16 v[80:95], v[108:111], a[76:79], v[80:95]
    ds_read_b128 v[108:111], v21 offset:256
    s_waitcnt lgkmcnt(7)
    v_mfma_f32_32x32x16_bf16 v[80:95], v[112:115], a[80:83], v[80:95]
    ds_read_b128 v[112:115], v22 offset:256
    s_waitcnt lgkmcnt(7)
    v_mfma_f32_32x32x16_bf16 v[80:95], v[116:119], a[84:87], v[80:95]
    ds_read_b128 v[116:119], v23 offset:256
    s_waitcnt lgkmcnt(7)
    v_mfma_f32_32x32x16_bf16 v[80:95], v[120:123], a[88:91], v[80:95]
    ds_read_b128 v[120:123], v24 offset:256
    s_waitcnt lgkmcnt(7)
    v_mfma_f32_32x32x16_bf16 v[80:95], v[124:127], a[92:95], v[80:95]
    ds_read_b128 v[124:127], v25 offset:256
    s_waitcnt lgkmcnt(7)
    v_mfma_f32_32x32x16_bf16 v[80:95], v[96:99], a[96:99], v[80:95]
    s_waitcnt lgkmcnt(6)
    v_mfma_f32_32x32x16_bf16 v[80:95], v[100:103], a[100:103], v[80:95]
    s_waitcnt lgkmcnt(5)
    v_mfma_f32_32x32x16_bf16 v[80:95], v[104:107], a[104:107], v[80:95]
    s_waitcnt lgkmcnt(4)
    v_mfma_f32_32x32x16_bf16 v[80:95], v[108:111], a[108:111], v[80:95]
    s_waitcnt lgkmcnt(3)
    v_mfma_f32_32x32x16_bf16 v[80:95], v[112:115], a[112:115], v[80:95]
    s_waitcnt lgkmcnt(2)
    v_mfma_f32_32x32x16_bf16 v[80:95], v[116:119], a[116:119], v[80:95]
    s_waitcnt lgkmcnt(1)
    v_mfma_f32_32x32x16_bf16 v[80:95], v[120:123], a[120:123], v[80:95]
    s_waitcnt lgkmcnt(0)
    v_mfma_f32_32x32x16_bf16 v[80:95], v[124:127], a[124:127], v[80:95]
    s_add_u32 m0, s52, 18432
    s_mov_b32 s53, 57344
    buffer_load_dwordx4 v9, s[24:27], s53 offen nt lds
    s_add_u32 m0, s52, 19456
    s_mov_b32 s53, 61440
    buffer_load_dwordx4 v9, s[24:27], s53 offen nt lds
    s_mov_b32 s53, 43008
    buffer_load_dwordx4 v[224:227], v14, s[40:43], s53 offen
    s_nop 11
    v_max3_f32 v26, v32, v33, v34
    v_max3_f32 v27, v35, v36, v37
    v_max3_f32 v26, v26, v38, v39
    v_max3_f32 v27, v27, v40, v41
    v_max3_f32 v26, v26, v42, v43
    v_max3_f32 v27, v27, v44, v45
    v_max3_f32 v26, v26, v46, v47
    v_max3_f32 v27, v27, v48, v49
    v_max3_f32 v26, v26, v50, v51
    v_max3_f32 v27, v27, v52, v53
    v_max3_f32 v26, v26, v54, v55
    v_max3_f32 v27, v27, v56, v57
    v_max3_f32 v26, v26, v58, v59
    v_max3_f32 v27, v27, v60, v61
    v_max3_f32 v26, v26, v62, v63
    v_max3_f32 v27, v27, v64, v65
    v_max3_f32 v26, v26, v66, v67
    v_max3_f32 v27, v27, v68, v69
    v_max3_f32 v26, v26, v70, v71
    v_max3_f32 v27, v27, v72, v73
    v_max3_f32 v26, v26, v74, v75
    v_max3_f32 v27, v27, v76, v77
    v_max3_f32 v26, v26, v78, v79
    v_max3_f32 v27, v27, v80, v81
    v_max3_f32 v26, v26, v82, v83
    v_max3_f32 v27, v27, v84, v85
    v_max3_f32 v26, v26, v86, v87
    v_max3_f32 v27, v27, v88, v89
    v_max3_f32 v26, v26, v90, v91
    v_max3_f32 v27, v27, v92, v93
    v_max3_f32 v26, v26, v94, v95
    v_max_f32 v26, v26, v27
    s_lshl_b32 s54, s48, 8
    s_add_u32 s54, s54, 155648
    v_lshlrev_b32 v28, 2, v0
    v_add_u32 v29, s54, v28
    ds_write_b32 v29, v26
    s_add_u32 m0, s52, 20480
    s_mov_b32 s53, 65536
    buffer_load_dwordx4 v9, s[24:27], s53 offen nt lds
    v_and_b32 v30, 31, v0
    v_lshlrev_b32 v30, 2, v30
    v_add_u32 v30, 155648, v30
    s_waitcnt lgkmcnt(0)
    s_barrier
    ds_read2_b32 v[96:97], v30 offset0:0 offset1:32
    ds_read2_b32 v[98:99], v30 offset0:64 offset1:96
    ds_read2_b32 v[100:101], v30 offset0:128 offset1:160
    ds_read2_b32 v[102:103], v30 offset0:192 offset1:224
    s_waitcnt lgkmcnt(0)
    v_max3_f32 v26, v96, v97, v98
    v_max3_f32 v27, v99, v100, v101
    v_max3_f32 v26, v26, v102, v103
    v_max_f32 v26, v26, v27
    s_mov_b32 s62, 0x3db8aa3b
    v_mul_f32 v31, s62, v26
    v_mov_b32 v26, 0
    v_mov_b32 v27, 0
    v_fma_f32 v32, v32, s62, -v31
    v_fma_f32 v33, v33, s62, -v31
    v_fma_f32 v34, v34, s62, -v31
    v_fma_f32 v35, v35, s62, -v31
    v_fma_f32 v36, v36, s62, -v31
    v_fma_f32 v37, v37, s62, -v31
    v_fma_f32 v38, v38, s62, -v31
    v_fma_f32 v39, v39, s62, -v31
    v_exp_f32 v32, v32
    v_exp_f32 v33, v33
    v_exp_f32 v34, v34
    v_exp_f32 v35, v35
    v_exp_f32 v36, v36
    v_exp_f32 v37, v37
    v_exp_f32 v38, v38
    v_exp_f32 v39, v39
    s_add_u32 m0, s52, 21504
    s_mov_b32 s53, 69632
    buffer_load_dwordx4 v9, s[24:27], s53 offen nt lds
    s_mov_b32 s53, 43904
    buffer_load_dwordx4 v[228:231], v14, s[40:43], s53 offen
    s_add_u32 m0, s52, 22528
    s_mov_b32 s53, 73728
    buffer_load_dwordx4 v9, s[24:27], s53 offen nt lds
    v_add_f32 v26, v26, v32
    v_add_f32 v27, v27, v33
    v_cvt_pk_bf16_f32 v96, v32, v33
    v_add_f32 v26, v26, v34
    v_add_f32 v27, v27, v35
    v_cvt_pk_bf16_f32 v97, v34, v35
    v_add_f32 v26, v26, v36
    v_add_f32 v27, v27, v37
    v_cvt_pk_bf16_f32 v98, v36, v37
    v_add_f32 v26, v26, v38
    v_add_f32 v27, v27, v39
    v_cvt_pk_bf16_f32 v99, v38, v39
    ds_write_b128 v13, v[96:99] offset:0
    v_fma_f32 v40, v40, s62, -v31
    v_fma_f32 v41, v41, s62, -v31
    v_fma_f32 v42, v42, s62, -v31
    v_fma_f32 v43, v43, s62, -v31
    v_fma_f32 v44, v44, s62, -v31
    v_fma_f32 v45, v45, s62, -v31
    v_fma_f32 v46, v46, s62, -v31
    v_fma_f32 v47, v47, s62, -v31
    v_exp_f32 v40, v40
    v_exp_f32 v41, v41
    v_exp_f32 v42, v42
    v_exp_f32 v43, v43
    v_exp_f32 v44, v44
    v_exp_f32 v45, v45
    v_exp_f32 v46, v46
    v_exp_f32 v47, v47
    s_add_u32 m0, s52, 23552
    s_mov_b32 s53, 77824
    buffer_load_dwordx4 v9, s[24:27], s53 offen nt lds
    s_mov_b32 s53, 44800
    buffer_load_dwordx4 v[232:235], v14, s[40:43], s53 offen
    v_add_f32 v26, v26, v40
    v_add_f32 v27, v27, v41
    v_cvt_pk_bf16_f32 v100, v40, v41
    v_add_f32 v26, v26, v42
    v_add_f32 v27, v27, v43
    v_cvt_pk_bf16_f32 v101, v42, v43
    v_add_f32 v26, v26, v44
    v_add_f32 v27, v27, v45
    v_cvt_pk_bf16_f32 v102, v44, v45
    v_add_f32 v26, v26, v46
    v_add_f32 v27, v27, v47
    v_cvt_pk_bf16_f32 v103, v46, v47
    ds_write_b128 v13, v[100:103] offset:1024
    s_waitcnt lgkmcnt(1)
    v_fma_f32 v48, v48, s62, -v31
    v_fma_f32 v49, v49, s62, -v31
    v_fma_f32 v50, v50, s62, -v31
    v_fma_f32 v51, v51, s62, -v31
    v_fma_f32 v52, v52, s62, -v31
    v_fma_f32 v53, v53, s62, -v31
    v_fma_f32 v54, v54, s62, -v31
    v_fma_f32 v55, v55, s62, -v31
    v_exp_f32 v48, v48
    v_exp_f32 v49, v49
    v_exp_f32 v50, v50
    v_exp_f32 v51, v51
    v_exp_f32 v52, v52
    v_exp_f32 v53, v53
    v_exp_f32 v54, v54
    v_exp_f32 v55, v55
    s_add_u32 m0, s52, 24576
    s_mov_b32 s53, 81920
    buffer_load_dwordx4 v9, s[24:27], s53 offen nt lds
    v_add_f32 v26, v26, v48
    v_add_f32 v27, v27, v49
    v_cvt_pk_bf16_f32 v96, v48, v49
    v_add_f32 v26, v26, v50
    v_add_f32 v27, v27, v51
    v_cvt_pk_bf16_f32 v97, v50, v51
    v_add_f32 v26, v26, v52
    v_add_f32 v27, v27, v53
    v_cvt_pk_bf16_f32 v98, v52, v53
    v_add_f32 v26, v26, v54
    v_add_f32 v27, v27, v55
    v_cvt_pk_bf16_f32 v99, v54, v55
    ds_write_b128 v13, v[96:99] offset:2048
    s_waitcnt lgkmcnt(1)
    v_fma_f32 v56, v56, s62, -v31
    v_fma_f32 v57, v57, s62, -v31
    v_fma_f32 v58, v58, s62, -v31
    v_fma_f32 v59, v59, s62, -v31
    v_fma_f32 v60, v60, s62, -v31
    v_fma_f32 v61, v61, s62, -v31
    v_fma_f32 v62, v62, s62, -v31
    v_fma_f32 v63, v63, s62, -v31
    v_exp_f32 v56, v56
    v_exp_f32 v57, v57
    v_exp_f32 v58, v58
    v_exp_f32 v59, v59
    v_exp_f32 v60, v60
    v_exp_f32 v61, v61
    v_exp_f32 v62, v62
    v_exp_f32 v63, v63
    s_add_u32 m0, s52, 25600
    s_mov_b32 s53, 86016
    buffer_load_dwordx4 v9, s[24:27], s53 offen nt lds
    s_mov_b32 s53, 45696
    buffer_load_dwordx4 v[236:239], v14, s[40:43], s53 offen
    v_add_f32 v26, v26, v56
    v_add_f32 v27, v27, v57
    v_cvt_pk_bf16_f32 v100, v56, v57
    v_add_f32 v26, v26, v58
    v_add_f32 v27, v27, v59
    v_cvt_pk_bf16_f32 v101, v58, v59
    v_add_f32 v26, v26, v60
    v_add_f32 v27, v27, v61
    v_cvt_pk_bf16_f32 v102, v60, v61
    v_add_f32 v26, v26, v62
    v_add_f32 v27, v27, v63
    v_cvt_pk_bf16_f32 v103, v62, v63
    ds_write_b128 v13, v[100:103] offset:3072
    s_waitcnt lgkmcnt(1)
    v_fma_f32 v64, v64, s62, -v31
    v_fma_f32 v65, v65, s62, -v31
    v_fma_f32 v66, v66, s62, -v31
    v_fma_f32 v67, v67, s62, -v31
    v_fma_f32 v68, v68, s62, -v31
    v_fma_f32 v69, v69, s62, -v31
    v_fma_f32 v70, v70, s62, -v31
    v_fma_f32 v71, v71, s62, -v31
    v_exp_f32 v64, v64
    v_exp_f32 v65, v65
    v_exp_f32 v66, v66
    v_exp_f32 v67, v67
    v_exp_f32 v68, v68
    v_exp_f32 v69, v69
    v_exp_f32 v70, v70
    v_exp_f32 v71, v71
    s_add_u32 m0, s52, 26624
    s_mov_b32 s53, 90112
    buffer_load_dwordx4 v9, s[24:27], s53 offen nt lds
    v_add_f32 v26, v26, v64
    v_add_f32 v27, v27, v65
    v_cvt_pk_bf16_f32 v96, v64, v65
    v_add_f32 v26, v26, v66
    v_add_f32 v27, v27, v67
    v_cvt_pk_bf16_f32 v97, v66, v67
    v_add_f32 v26, v26, v68
    v_add_f32 v27, v27, v69
    v_cvt_pk_bf16_f32 v98, v68, v69
    v_add_f32 v26, v26, v70
    v_add_f32 v27, v27, v71
    v_cvt_pk_bf16_f32 v99, v70, v71
    ds_write_b128 v13, v[96:99] offset:4096
    s_waitcnt lgkmcnt(1)
    v_fma_f32 v72, v72, s62, -v31
    v_fma_f32 v73, v73, s62, -v31
    v_fma_f32 v74, v74, s62, -v31
    v_fma_f32 v75, v75, s62, -v31
    v_fma_f32 v76, v76, s62, -v31
    v_fma_f32 v77, v77, s62, -v31
    v_fma_f32 v78, v78, s62, -v31
    v_fma_f32 v79, v79, s62, -v31
    v_exp_f32 v72, v72
    v_exp_f32 v73, v73
    v_exp_f32 v74, v74
    v_exp_f32 v75, v75
    v_exp_f32 v76, v76
    v_exp_f32 v77, v77
    v_exp_f32 v78, v78
    v_exp_f32 v79, v79
    s_add_u32 m0, s52, 27648
    s_mov_b32 s53, 94208
    buffer_load_dwordx4 v9, s[24:27], s53 offen nt lds
    s_mov_b32 s53, 50176
    buffer_load_dwordx4 v[240:243], v14, s[40:43], s53 offen
    v_add_f32 v26, v26, v72
    v_add_f32 v27, v27, v73
    v_cvt_pk_bf16_f32 v100, v72, v73
    v_add_f32 v26, v26, v74
    v_add_f32 v27, v27, v75
    v_cvt_pk_bf16_f32 v101, v74, v75
    v_add_f32 v26, v26, v76
    v_add_f32 v27, v27, v77
    v_cvt_pk_bf16_f32 v102, v76, v77
    v_add_f32 v26, v26, v78
    v_add_f32 v27, v27, v79
    v_cvt_pk_bf16_f32 v103, v78, v79
    ds_write_b128 v13, v[100:103] offset:5120
    s_waitcnt lgkmcnt(1)
    v_fma_f32 v80, v80, s62, -v31
    v_fma_f32 v81, v81, s62, -v31
    v_fma_f32 v82, v82, s62, -v31
    v_fma_f32 v83, v83, s62, -v31
    v_fma_f32 v84, v84, s62, -v31
    v_fma_f32 v85, v85, s62, -v31
    v_fma_f32 v86, v86, s62, -v31
    v_fma_f32 v87, v87, s62, -v31
    v_exp_f32 v80, v80
    v_exp_f32 v81, v81
    v_exp_f32 v82, v82
    v_exp_f32 v83, v83
    v_exp_f32 v84, v84
    v_exp_f32 v85, v85
    v_exp_f32 v86, v86
    v_exp_f32 v87, v87
    s_add_u32 m0, s52, 28672
    s_mov_b32 s53, 98304
    buffer_load_dwordx4 v9, s[24:27], s53 offen nt lds
    v_add_f32 v26, v26, v80
    v_add_f32 v27, v27, v81
    v_cvt_pk_bf16_f32 v96, v80, v81
    v_add_f32 v26, v26, v82
    v_add_f32 v27, v27, v83
    v_cvt_pk_bf16_f32 v97, v82, v83
    v_add_f32 v26, v26, v84
    v_add_f32 v27, v27, v85
    v_cvt_pk_bf16_f32 v98, v84, v85
    v_add_f32 v26, v26, v86
    v_add_f32 v27, v27, v87
    v_cvt_pk_bf16_f32 v99, v86, v87
    ds_write_b128 v13, v[96:99] offset:6144
    s_waitcnt lgkmcnt(1)
    v_fma_f32 v88, v88, s62, -v31
    v_fma_f32 v89, v89, s62, -v31
    v_fma_f32 v90, v90, s62, -v31
    v_fma_f32 v91, v91, s62, -v31
    v_fma_f32 v92, v92, s62, -v31
    v_fma_f32 v93, v93, s62, -v31
    v_fma_f32 v94, v94, s62, -v31
    v_fma_f32 v95, v95, s62, -v31
    v_exp_f32 v88, v88
    v_exp_f32 v89, v89
    v_exp_f32 v90, v90
    v_exp_f32 v91, v91
    v_exp_f32 v92, v92
    v_exp_f32 v93, v93
    v_exp_f32 v94, v94
    v_exp_f32 v95, v95
    s_add_u32 m0, s52, 29696
    s_mov_b32 s53, 102400
    buffer_load_dwordx4 v9, s[24:27], s53 offen nt lds
    s_mov_b32 s53, 51072
    buffer_load_dwordx4 v[244:247], v14, s[40:43], s53 offen
    v_add_f32 v26, v26, v88
    v_add_f32 v27, v27, v89
    v_cvt_pk_bf16_f32 v100, v88, v89
    v_add_f32 v26, v26, v90
    v_add_f32 v27, v27, v91
    v_cvt_pk_bf16_f32 v101, v90, v91
    v_add_f32 v26, v26, v92
    v_add_f32 v27, v27, v93
    v_cvt_pk_bf16_f32 v102, v92, v93
    v_add_f32 v26, v26, v94
    v_add_f32 v27, v27, v95
    v_cvt_pk_bf16_f32 v103, v94, v95
    ds_write_b128 v13, v[100:103] offset:7168
    s_waitcnt lgkmcnt(1)
    s_add_u32 m0, s52, 0
    s_mov_b32 s53, 106496
    buffer_load_dwordx4 v9, s[24:27], s53 offen nt lds
    s_add_u32 m0, s52, 1024
    s_mov_b32 s53, 110592
    buffer_load_dwordx4 v9, s[24:27], s53 offen nt lds
    s_mov_b32 s53, 51968
    buffer_load_dwordx4 v[248:251], v14, s[40:43], s53 offen
    v_add_f32 v26, v26, v27
    v_add_u32 v29, 1024, v29
    ds_write_b32 v29, v26
    v_add_u32 v30, 1024, v30
    s_waitcnt lgkmcnt(0)
    s_barrier
    ds_read2_b32 v[96:97], v30 offset0:0 offset1:32
    ds_read2_b32 v[98:99], v30 offset0:64 offset1:96
    ds_read2_b32 v[100:101], v30 offset0:128 offset1:160
    ds_read2_b32 v[102:103], v30 offset0:192 offset1:224
    s_waitcnt lgkmcnt(0)
    v_add_f32 v96, v96, v97
    v_add_f32 v98, v98, v99
    v_add_f32 v100, v100, v101
    v_add_f32 v102, v102, v103
    v_add_f32 v96, v96, v98
    v_add_f32 v100, v100, v102
    v_add_f32 v30, v96, v100
    s_add_u32 m0, s52, 2048
    s_mov_b32 s53, 114688
    buffer_load_dwordx4 v9, s[24:27], s53 offen nt lds
    s_add_u32 m0, s52, 3072
    s_mov_b32 s53, 118784
    buffer_load_dwordx4 v9, s[24:27], s53 offen nt lds
    s_mov_b32 s53, 52864
    buffer_load_dwordx4 v[252:255], v14, s[40:43], s53 offen
    s_waitcnt vmcnt(43)
    ds_read_b128 v[80:83], v12 offset:0
    ds_read_b64_tr_b16 v[64:65], v10 offset:4096
    ds_read_b64_tr_b16 v[66:67], v10 offset:5120
    ds_read_b64_tr_b16 v[68:69], v11 offset:4096
    ds_read_b64_tr_b16 v[70:71], v11 offset:5120
    s_waitcnt vmcnt(40)
    ds_read_b128 v[84:87], v12 offset:1024
    ds_read_b64_tr_b16 v[72:73], v10 offset:6144
    ds_read_b64_tr_b16 v[74:75], v10 offset:7168
    ds_read_b64_tr_b16 v[76:77], v11 offset:6144
    ds_read_b64_tr_b16 v[78:79], v11 offset:7168
    s_waitcnt lgkmcnt(5)
    v_mfma_f32_32x32x16_bf16 v[32:47], v[64:67], v[80:83], 0
    v_mfma_f32_32x32x16_bf16 v[48:63], v[68:71], v[80:83], 0
    s_add_u32 m0, s52, 4096
    s_mov_b32 s53, 122880
    buffer_load_dwordx4 v9, s[24:27], s53 offen nt lds
    s_add_u32 m0, s52, 5120
    s_mov_b32 s53, 126976
    buffer_load_dwordx4 v9, s[24:27], s53 offen nt lds
    v_perm_b32 v96, v132, v128, s60
    v_perm_b32 v97, v140, v136, s60
    v_perm_b32 v98, v148, v144, s60
    v_perm_b32 v99, v156, v152, s60
    v_perm_b32 v100, v132, v128, s61
    v_perm_b32 v101, v140, v136, s61
    v_perm_b32 v102, v148, v144, s61
    v_perm_b32 v103, v156, v152, s61
    s_waitcnt vmcnt(39)
    ds_read_b128 v[80:83], v12 offset:2048
    ds_read_b64_tr_b16 v[64:65], v10 offset:8192
    ds_read_b64_tr_b16 v[66:67], v10 offset:9216
    ds_read_b64_tr_b16 v[68:69], v11 offset:8192
    ds_read_b64_tr_b16 v[70:71], v11 offset:9216
    s_waitcnt lgkmcnt(5)
    v_mfma_f32_32x32x16_bf16 v[32:47], v[72:75], v[84:87], v[32:47]
    v_mfma_f32_32x32x16_bf16 v[48:63], v[76:79], v[84:87], v[48:63]
    s_add_u32 m0, s52, 6144
    s_mov_b32 s53, 131072
    buffer_load_dwordx4 v9, s[24:27], s53 offen nt lds
    s_add_u32 m0, s52, 7168
    s_mov_b32 s53, 135168
    buffer_load_dwordx4 v9, s[24:27], s53 offen nt lds
    v_perm_b32 v104, v133, v129, s60
    v_perm_b32 v105, v141, v137, s60
    v_perm_b32 v106, v149, v145, s60
    v_perm_b32 v107, v157, v153, s60
    v_perm_b32 v108, v133, v129, s61
    v_perm_b32 v109, v141, v137, s61
    v_perm_b32 v110, v149, v145, s61
    v_perm_b32 v111, v157, v153, s61
    s_waitcnt vmcnt(38)
    ds_read_b128 v[84:87], v12 offset:3072
    ds_read_b64_tr_b16 v[72:73], v10 offset:10240
    ds_read_b64_tr_b16 v[74:75], v10 offset:11264
    ds_read_b64_tr_b16 v[76:77], v11 offset:10240
    ds_read_b64_tr_b16 v[78:79], v11 offset:11264
    s_waitcnt lgkmcnt(5)
    v_mfma_f32_32x32x16_bf16 v[32:47], v[64:67], v[80:83], v[32:47]
    v_mfma_f32_32x32x16_bf16 v[48:63], v[68:71], v[80:83], v[48:63]
    s_add_u32 m0, s52, 8192
    s_mov_b32 s53, 139264
    buffer_load_dwordx4 v9, s[24:27], s53 offen nt lds
    s_add_u32 m0, s52, 9216
    s_mov_b32 s53, 143360
    buffer_load_dwordx4 v9, s[24:27], s53 offen nt lds
    v_perm_b32 v112, v134, v130, s60
    v_perm_b32 v113, v142, v138, s60
    v_perm_b32 v114, v150, v146, s60
    v_perm_b32 v115, v158, v154, s60
    v_perm_b32 v116, v134, v130, s61
    v_perm_b32 v117, v142, v138, s61
    v_perm_b32 v118, v150, v146, s61
    v_perm_b32 v119, v158, v154, s61
    s_waitcnt vmcnt(37)
    ds_read_b128 v[80:83], v12 offset:4096
    ds_read_b64_tr_b16 v[64:65], v10 offset:12288
    ds_read_b64_tr_b16 v[66:67], v10 offset:13312
    ds_read_b64_tr_b16 v[68:69], v11 offset:12288
    ds_read_b64_tr_b16 v[70:71], v11 offset:13312
    s_waitcnt lgkmcnt(5)
    v_mfma_f32_32x32x16_bf16 v[32:47], v[72:75], v[84:87], v[32:47]
    v_mfma_f32_32x32x16_bf16 v[48:63], v[76:79], v[84:87], v[48:63]
    s_add_u32 m0, s52, 10240
    s_mov_b32 s53, 147456
    buffer_load_dwordx4 v9, s[24:27], s53 offen nt lds
    s_add_u32 m0, s52, 11264
    s_mov_b32 s53, 151552
    buffer_load_dwordx4 v9, s[24:27], s53 offen nt lds
    v_perm_b32 v120, v135, v131, s60
    v_perm_b32 v121, v143, v139, s60
    v_perm_b32 v122, v151, v147, s60
    v_perm_b32 v123, v159, v155, s60
    v_perm_b32 v124, v135, v131, s61
    v_perm_b32 v125, v143, v139, s61
    v_perm_b32 v126, v151, v147, s61
    v_perm_b32 v127, v159, v155, s61
    s_waitcnt vmcnt(36)
    ds_read_b128 v[84:87], v12 offset:5120
    ds_read_b64_tr_b16 v[72:73], v10 offset:14336
    ds_read_b64_tr_b16 v[74:75], v10 offset:15360
    ds_read_b64_tr_b16 v[76:77], v11 offset:14336
    ds_read_b64_tr_b16 v[78:79], v11 offset:15360
    s_waitcnt lgkmcnt(5)
    v_mfma_f32_32x32x16_bf16 v[32:47], v[64:67], v[80:83], v[32:47]
    v_mfma_f32_32x32x16_bf16 v[48:63], v[68:71], v[80:83], v[48:63]
    s_add_u32 m0, s52, 12288
    s_mov_b32 s53, 155648
    buffer_load_dwordx4 v9, s[24:27], s53 offen nt lds
    s_add_u32 m0, s52, 13312
    s_mov_b32 s53, 159744
    buffer_load_dwordx4 v9, s[24:27], s53 offen nt lds
    v_perm_b32 v128, v164, v160, s60
    v_perm_b32 v129, v172, v168, s60
    v_perm_b32 v130, v180, v176, s60
    v_perm_b32 v131, v188, v184, s60
    v_perm_b32 v132, v164, v160, s61
    v_perm_b32 v133, v172, v168, s61
    v_perm_b32 v134, v180, v176, s61
    v_perm_b32 v135, v188, v184, s61
    s_waitcnt vmcnt(35)
    ds_read_b128 v[80:83], v12 offset:6144
    ds_read_b64_tr_b16 v[64:65], v10 offset:16384
    ds_read_b64_tr_b16 v[66:67], v10 offset:17408
    ds_read_b64_tr_b16 v[68:69], v11 offset:16384
    ds_read_b64_tr_b16 v[70:71], v11 offset:17408
    s_waitcnt lgkmcnt(5)
    v_mfma_f32_32x32x16_bf16 v[32:47], v[72:75], v[84:87], v[32:47]
    v_mfma_f32_32x32x16_bf16 v[48:63], v[76:79], v[84:87], v[48:63]
    s_add_u32 m0, s52, 14336
    s_mov_b32 s53, 163840
    buffer_load_dwordx4 v9, s[24:27], s53 offen nt lds
    s_add_u32 m0, s52, 15360
    s_mov_b32 s53, 167936
    buffer_load_dwordx4 v9, s[24:27], s53 offen nt lds
    v_perm_b32 v136, v165, v161, s60
    v_perm_b32 v137, v173, v169, s60
    v_perm_b32 v138, v181, v177, s60
    v_perm_b32 v139, v189, v185, s60
    v_perm_b32 v140, v165, v161, s61
    v_perm_b32 v141, v173, v169, s61
    v_perm_b32 v142, v181, v177, s61
    v_perm_b32 v143, v189, v185, s61
    s_waitcnt vmcnt(34)
    ds_read_b128 v[84:87], v12 offset:7168
    ds_read_b64_tr_b16 v[72:73], v10 offset:18432
    ds_read_b64_tr_b16 v[74:75], v10 offset:19456
    ds_read_b64_tr_b16 v[76:77], v11 offset:18432
    ds_read_b64_tr_b16 v[78:79], v11 offset:19456
    s_waitcnt lgkmcnt(5)
    v_mfma_f32_32x32x16_bf16 v[32:47], v[64:67], v[80:83], v[32:47]
    v_mfma_f32_32x32x16_bf16 v[48:63], v[68:71], v[80:83], v[48:63]
    s_add_u32 m0, s52, 16384
    s_mov_b32 s53, 172032
    buffer_load_dwordx4 v9, s[24:27], s53 offen nt lds
    s_add_u32 m0, s52, 17408
    s_mov_b32 s53, 176128
    buffer_load_dwordx4 v9, s[24:27], s53 offen nt lds
    v_perm_b32 v144, v166, v162, s60
    v_perm_b32 v145, v174, v170, s60
    v_perm_b32 v146, v182, v178, s60
    v_perm_b32 v147, v190, v186, s60
    v_perm_b32 v148, v166, v162, s61
    v_perm_b32 v149, v174, v170, s61
    v_perm_b32 v150, v182, v178, s61
    v_perm_b32 v151, v190, v186, s61
    s_waitcnt vmcnt(33)
    ds_read_b128 v[80:83], v12 offset:8192
    ds_read_b64_tr_b16 v[64:65], v10 offset:20480
    ds_read_b64_tr_b16 v[66:67], v10 offset:21504
    ds_read_b64_tr_b16 v[68:69], v11 offset:20480
    ds_read_b64_tr_b16 v[70:71], v11 offset:21504
    s_waitcnt lgkmcnt(5)
    v_mfma_f32_32x32x16_bf16 v[32:47], v[72:75], v[84:87], v[32:47]
    v_mfma_f32_32x32x16_bf16 v[48:63], v[76:79], v[84:87], v[48:63]
    s_add_u32 m0, s52, 18432
    s_mov_b32 s53, 180224
    buffer_load_dwordx4 v9, s[24:27], s53 offen nt lds
    s_add_u32 m0, s52, 19456
    s_mov_b32 s53, 184320
    buffer_load_dwordx4 v9, s[24:27], s53 offen nt lds
    v_perm_b32 v152, v167, v163, s60
    v_perm_b32 v153, v175, v171, s60
    v_perm_b32 v154, v183, v179, s60
    v_perm_b32 v155, v191, v187, s60
    v_perm_b32 v156, v167, v163, s61
    v_perm_b32 v157, v175, v171, s61
    v_perm_b32 v158, v183, v179, s61
    v_perm_b32 v159, v191, v187, s61
    s_waitcnt vmcnt(32)
    ds_read_b128 v[84:87], v12 offset:9216
    ds_read_b64_tr_b16 v[72:73], v10 offset:22528
    ds_read_b64_tr_b16 v[74:75], v10 offset:23552
    ds_read_b64_tr_b16 v[76:77], v11 offset:22528
    ds_read_b64_tr_b16 v[78:79], v11 offset:23552
    s_waitcnt lgkmcnt(5)
    v_mfma_f32_32x32x16_bf16 v[32:47], v[64:67], v[80:83], v[32:47]
    v_mfma_f32_32x32x16_bf16 v[48:63], v[68:71], v[80:83], v[48:63]
    s_add_u32 m0, s52, 20480
    s_mov_b32 s53, 188416
    buffer_load_dwordx4 v9, s[24:27], s53 offen nt lds
    s_add_u32 m0, s52, 21504
    s_mov_b32 s53, 192512
    buffer_load_dwordx4 v9, s[24:27], s53 offen nt lds
    v_perm_b32 v160, v196, v192, s60
    v_perm_b32 v161, v204, v200, s60
    v_perm_b32 v162, v212, v208, s60
    v_perm_b32 v163, v220, v216, s60
    v_perm_b32 v164, v196, v192, s61
    v_perm_b32 v165, v204, v200, s61
    v_perm_b32 v166, v212, v208, s61
    v_perm_b32 v167, v220, v216, s61
    s_waitcnt vmcnt(31)
    ds_read_b128 v[80:83], v12 offset:10240
    ds_read_b64_tr_b16 v[64:65], v10 offset:24576
    ds_read_b64_tr_b16 v[66:67], v10 offset:25600
    ds_read_b64_tr_b16 v[68:69], v11 offset:24576
    ds_read_b64_tr_b16 v[70:71], v11 offset:25600
    s_waitcnt lgkmcnt(5)
    v_mfma_f32_32x32x16_bf16 v[32:47], v[72:75], v[84:87], v[32:47]
    v_mfma_f32_32x32x16_bf16 v[48:63], v[76:79], v[84:87], v[48:63]
    s_add_u32 m0, s52, 22528
    s_mov_b32 s53, 196608
    buffer_load_dwordx4 v9, s[24:27], s53 offen nt lds
    s_add_u32 m0, s52, 23552
    s_mov_b32 s53, 200704
    buffer_load_dwordx4 v9, s[24:27], s53 offen nt lds
    v_perm_b32 v168, v197, v193, s60
    v_perm_b32 v169, v205, v201, s60
    v_perm_b32 v170, v213, v209, s60
    v_perm_b32 v171, v221, v217, s60
    v_perm_b32 v172, v197, v193, s61
    v_perm_b32 v173, v205, v201, s61
    v_perm_b32 v174, v213, v209, s61
    v_perm_b32 v175, v221, v217, s61
    s_waitcnt vmcnt(30)
    ds_read_b128 v[84:87], v12 offset:11264
    ds_read_b64_tr_b16 v[72:73], v10 offset:26624
    ds_read_b64_tr_b16 v[74:75], v10 offset:27648
    ds_read_b64_tr_b16 v[76:77], v11 offset:26624
    ds_read_b64_tr_b16 v[78:79], v11 offset:27648
    s_waitcnt lgkmcnt(5)
    v_mfma_f32_32x32x16_bf16 v[32:47], v[64:67], v[80:83], v[32:47]
    v_mfma_f32_32x32x16_bf16 v[48:63], v[68:71], v[80:83], v[48:63]
    s_add_u32 m0, s52, 24576
    s_mov_b32 s53, 204800
    buffer_load_dwordx4 v9, s[24:27], s53 offen nt lds
    s_add_u32 m0, s52, 25600
    s_mov_b32 s53, 208896
    buffer_load_dwordx4 v9, s[24:27], s53 offen nt lds
    v_perm_b32 v176, v198, v194, s60
    v_perm_b32 v177, v206, v202, s60
    v_perm_b32 v178, v214, v210, s60
    v_perm_b32 v179, v222, v218, s60
    v_perm_b32 v180, v198, v194, s61
    v_perm_b32 v181, v206, v202, s61
    v_perm_b32 v182, v214, v210, s61
    v_perm_b32 v183, v222, v218, s61
    s_waitcnt vmcnt(29)
    ds_read_b128 v[80:83], v12 offset:12288
    ds_read_b64_tr_b16 v[64:65], v10 offset:28672
    ds_read_b64_tr_b16 v[66:67], v10 offset:29696
    ds_read_b64_tr_b16 v[68:69], v11 offset:28672
    ds_read_b64_tr_b16 v[70:71], v11 offset:29696
    s_waitcnt lgkmcnt(5)
    v_mfma_f32_32x32x16_bf16 v[32:47], v[72:75], v[84:87], v[32:47]
    v_mfma_f32_32x32x16_bf16 v[48:63], v[76:79], v[84:87], v[48:63]
    s_add_u32 m0, s52, 26624
    s_mov_b32 s53, 212992
    buffer_load_dwordx4 v9, s[24:27], s53 offen nt lds
    s_add_u32 m0, s52, 27648
    s_mov_b32 s53, 217088
    buffer_load_dwordx4 v9, s[24:27], s53 offen nt lds
    v_perm_b32 v184, v199, v195, s60
    v_perm_b32 v185, v207, v203, s60
    v_perm_b32 v186, v215, v211, s60
    v_perm_b32 v187, v223, v219, s60
    v_perm_b32 v188, v199, v195, s61
    v_perm_b32 v189, v207, v203, s61
    v_perm_b32 v190, v215, v211, s61
    v_perm_b32 v191, v223, v219, s61
    s_waitcnt vmcnt(28)
    ds_read_b128 v[84:87], v12 offset:13312
    ds_read_b64_tr_b16 v[72:73], v10 offset:0
    ds_read_b64_tr_b16 v[74:75], v10 offset:1024
    ds_read_b64_tr_b16 v[76:77], v11 offset:0
    ds_read_b64_tr_b16 v[78:79], v11 offset:1024
    s_waitcnt lgkmcnt(5)
    v_mfma_f32_32x32x16_bf16 v[32:47], v[64:67], v[80:83], v[32:47]
    v_mfma_f32_32x32x16_bf16 v[48:63], v[68:71], v[80:83], v[48:63]
    s_add_u32 m0, s52, 28672
    s_mov_b32 s53, 221184
    buffer_load_dwordx4 v9, s[24:27], s53 offen nt lds
    s_add_u32 m0, s52, 29696
    s_mov_b32 s53, 225280
    buffer_load_dwordx4 v9, s[24:27], s53 offen nt lds
    s_waitcnt vmcnt(26)
    v_perm_b32 v192, v228, v224, s60
    v_perm_b32 v193, v236, v232, s60
    v_perm_b32 v194, v244, v240, s60
    v_perm_b32 v195, v252, v248, s60
    v_perm_b32 v196, v228, v224, s61
    v_perm_b32 v197, v236, v232, s61
    v_perm_b32 v198, v244, v240, s61
    v_perm_b32 v199, v252, v248, s61
    ds_read_b128 v[80:83], v12 offset:14336
    ds_read_b64_tr_b16 v[64:65], v10 offset:2048
    ds_read_b64_tr_b16 v[66:67], v10 offset:3072
    ds_read_b64_tr_b16 v[68:69], v11 offset:2048
    ds_read_b64_tr_b16 v[70:71], v11 offset:3072
    s_waitcnt lgkmcnt(5)
    v_mfma_f32_32x32x16_bf16 v[32:47], v[72:75], v[84:87], v[32:47]
    v_mfma_f32_32x32x16_bf16 v[48:63], v[76:79], v[84:87], v[48:63]
    s_add_u32 m0, s52, 0
    s_mov_b32 s53, 229376
    buffer_load_dwordx4 v9, s[24:27], s53 offen nt lds
    s_add_u32 m0, s52, 1024
    s_mov_b32 s53, 233472
    buffer_load_dwordx4 v9, s[24:27], s53 offen nt lds
    v_perm_b32 v200, v229, v225, s60
    v_perm_b32 v201, v237, v233, s60
    v_perm_b32 v202, v245, v241, s60
    v_perm_b32 v203, v253, v249, s60
    v_perm_b32 v204, v229, v225, s61
    v_perm_b32 v205, v237, v233, s61
    v_perm_b32 v206, v245, v241, s61
    v_perm_b32 v207, v253, v249, s61
    s_waitcnt vmcnt(26)
    ds_read_b128 v[84:87], v12 offset:15360
    ds_read_b64_tr_b16 v[72:73], v10 offset:4096
    ds_read_b64_tr_b16 v[74:75], v10 offset:5120
    ds_read_b64_tr_b16 v[76:77], v11 offset:4096
    ds_read_b64_tr_b16 v[78:79], v11 offset:5120
    s_waitcnt lgkmcnt(5)
    v_mfma_f32_32x32x16_bf16 v[32:47], v[64:67], v[80:83], v[32:47]
    v_mfma_f32_32x32x16_bf16 v[48:63], v[68:71], v[80:83], v[48:63]
    s_add_u32 m0, s52, 2048
    s_mov_b32 s53, 237568
    buffer_load_dwordx4 v9, s[24:27], s53 offen nt lds
    s_add_u32 m0, s52, 3072
    s_mov_b32 s53, 241664
    buffer_load_dwordx4 v9, s[24:27], s53 offen nt lds
    v_perm_b32 v208, v230, v226, s60
    v_perm_b32 v209, v238, v234, s60
    v_perm_b32 v210, v246, v242, s60
    v_perm_b32 v211, v254, v250, s60
    v_perm_b32 v212, v230, v226, s61
    v_perm_b32 v213, v238, v234, s61
    v_perm_b32 v214, v246, v242, s61
    v_perm_b32 v215, v254, v250, s61
    s_waitcnt vmcnt(26)
    ds_read_b128 v[80:83], v12 offset:16384
    ds_read_b64_tr_b16 v[64:65], v10 offset:6144
    ds_read_b64_tr_b16 v[66:67], v10 offset:7168
    ds_read_b64_tr_b16 v[68:69], v11 offset:6144
    ds_read_b64_tr_b16 v[70:71], v11 offset:7168
    s_waitcnt lgkmcnt(5)
    v_mfma_f32_32x32x16_bf16 v[32:47], v[72:75], v[84:87], v[32:47]
    v_mfma_f32_32x32x16_bf16 v[48:63], v[76:79], v[84:87], v[48:63]
    s_add_u32 m0, s52, 4096
    s_mov_b32 s53, 245760
    buffer_load_dwordx4 v9, s[24:27], s53 offen nt lds
    s_add_u32 m0, s52, 5120
    s_mov_b32 s53, 249856
    buffer_load_dwordx4 v9, s[24:27], s53 offen nt lds
    v_perm_b32 v216, v231, v227, s60
    v_perm_b32 v217, v239, v235, s60
    v_perm_b32 v218, v247, v243, s60
    v_perm_b32 v219, v255, v251, s60
    v_perm_b32 v220, v231, v227, s61
    v_perm_b32 v221, v239, v235, s61
    v_perm_b32 v222, v247, v243, s61
    v_perm_b32 v223, v255, v251, s61
    s_waitcnt vmcnt(26)
    ds_read_b128 v[84:87], v12 offset:17408
    ds_read_b64_tr_b16 v[72:73], v10 offset:8192
    ds_read_b64_tr_b16 v[74:75], v10 offset:9216
    ds_read_b64_tr_b16 v[76:77], v11 offset:8192
    ds_read_b64_tr_b16 v[78:79], v11 offset:9216
    s_waitcnt lgkmcnt(5)
    v_mfma_f32_32x32x16_bf16 v[32:47], v[64:67], v[80:83], v[32:47]
    v_mfma_f32_32x32x16_bf16 v[48:63], v[68:71], v[80:83], v[48:63]
    s_add_u32 m0, s52, 6144
    s_mov_b32 s53, 253952
    buffer_load_dwordx4 v9, s[24:27], s53 offen nt lds
    s_add_u32 m0, s52, 7168
    s_mov_b32 s53, 258048
    buffer_load_dwordx4 v9, s[24:27], s53 offen nt lds
    s_waitcnt vmcnt(26)
    ds_read_b128 v[80:83], v12 offset:18432
    ds_read_b64_tr_b16 v[64:65], v10 offset:10240
    ds_read_b64_tr_b16 v[66:67], v10 offset:11264
    ds_read_b64_tr_b16 v[68:69], v11 offset:10240
    ds_read_b64_tr_b16 v[70:71], v11 offset:11264
    s_waitcnt lgkmcnt(5)
    v_mfma_f32_32x32x16_bf16 v[32:47], v[72:75], v[84:87], v[32:47]
    v_mfma_f32_32x32x16_bf16 v[48:63], v[76:79], v[84:87], v[48:63]
    s_waitcnt vmcnt(24)
    ds_read_b128 v[84:87], v12 offset:19456
    ds_read_b64_tr_b16 v[72:73], v10 offset:12288
    ds_read_b64_tr_b16 v[74:75], v10 offset:13312
    ds_read_b64_tr_b16 v[76:77], v11 offset:12288
    ds_read_b64_tr_b16 v[78:79], v11 offset:13312
    s_waitcnt lgkmcnt(5)
    v_mfma_f32_32x32x16_bf16 v[32:47], v[64:67], v[80:83], v[32:47]
    v_mfma_f32_32x32x16_bf16 v[48:63], v[68:71], v[80:83], v[48:63]
    s_waitcnt vmcnt(22)
    ds_read_b128 v[80:83], v12 offset:20480
    ds_read_b64_tr_b16 v[64:65], v10 offset:14336
    ds_read_b64_tr_b16 v[66:67], v10 offset:15360
    ds_read_b64_tr_b16 v[68:69], v11 offset:14336
    ds_read_b64_tr_b16 v[70:71], v11 offset:15360
    s_waitcnt lgkmcnt(5)
    v_mfma_f32_32x32x16_bf16 v[32:47], v[72:75], v[84:87], v[32:47]
    v_mfma_f32_32x32x16_bf16 v[48:63], v[76:79], v[84:87], v[48:63]
    s_waitcnt vmcnt(20)
    ds_read_b128 v[84:87], v12 offset:21504
    ds_read_b64_tr_b16 v[72:73], v10 offset:16384
    ds_read_b64_tr_b16 v[74:75], v10 offset:17408
    ds_read_b64_tr_b16 v[76:77], v11 offset:16384
    ds_read_b64_tr_b16 v[78:79], v11 offset:17408
    s_waitcnt lgkmcnt(5)
    v_mfma_f32_32x32x16_bf16 v[32:47], v[64:67], v[80:83], v[32:47]
    v_mfma_f32_32x32x16_bf16 v[48:63], v[68:71], v[80:83], v[48:63]
    s_waitcnt vmcnt(18)
    ds_read_b128 v[80:83], v12 offset:22528
    ds_read_b64_tr_b16 v[64:65], v10 offset:18432
    ds_read_b64_tr_b16 v[66:67], v10 offset:19456
    ds_read_b64_tr_b16 v[68:69], v11 offset:18432
    ds_read_b64_tr_b16 v[70:71], v11 offset:19456
    s_waitcnt lgkmcnt(5)
    v_mfma_f32_32x32x16_bf16 v[32:47], v[72:75], v[84:87], v[32:47]
    v_mfma_f32_32x32x16_bf16 v[48:63], v[76:79], v[84:87], v[48:63]
    s_waitcnt vmcnt(16)
    ds_read_b128 v[84:87], v12 offset:23552
    ds_read_b64_tr_b16 v[72:73], v10 offset:20480
    ds_read_b64_tr_b16 v[74:75], v10 offset:21504
    ds_read_b64_tr_b16 v[76:77], v11 offset:20480
    ds_read_b64_tr_b16 v[78:79], v11 offset:21504
    s_waitcnt lgkmcnt(5)
    v_mfma_f32_32x32x16_bf16 v[32:47], v[64:67], v[80:83], v[32:47]
    v_mfma_f32_32x32x16_bf16 v[48:63], v[68:71], v[80:83], v[48:63]
    s_waitcnt vmcnt(14)
    ds_read_b128 v[80:83], v12 offset:24576
    ds_read_b64_tr_b16 v[64:65], v10 offset:22528
    ds_read_b64_tr_b16 v[66:67], v10 offset:23552
    ds_read_b64_tr_b16 v[68:69], v11 offset:22528
    ds_read_b64_tr_b16 v[70:71], v11 offset:23552
    s_waitcnt lgkmcnt(5)
    v_mfma_f32_32x32x16_bf16 v[32:47], v[72:75], v[84:87], v[32:47]
    v_mfma_f32_32x32x16_bf16 v[48:63], v[76:79], v[84:87], v[48:63]
    s_waitcnt vmcnt(12)
    ds_read_b128 v[84:87], v12 offset:25600
    ds_read_b64_tr_b16 v[72:73], v10 offset:24576
    ds_read_b64_tr_b16 v[74:75], v10 offset:25600
    ds_read_b64_tr_b16 v[76:77], v11 offset:24576
    ds_read_b64_tr_b16 v[78:79], v11 offset:25600
    s_waitcnt lgkmcnt(5)
    v_mfma_f32_32x32x16_bf16 v[32:47], v[64:67], v[80:83], v[32:47]
    v_mfma_f32_32x32x16_bf16 v[48:63], v[68:71], v[80:83], v[48:63]
    s_waitcnt vmcnt(10)
    ds_read_b128 v[80:83], v12 offset:26624
    ds_read_b64_tr_b16 v[64:65], v10 offset:26624
    ds_read_b64_tr_b16 v[66:67], v10 offset:27648
    ds_read_b64_tr_b16 v[68:69], v11 offset:26624
    ds_read_b64_tr_b16 v[70:71], v11 offset:27648
    s_waitcnt lgkmcnt(5)
    v_mfma_f32_32x32x16_bf16 v[32:47], v[72:75], v[84:87], v[32:47]
    v_mfma_f32_32x32x16_bf16 v[48:63], v[76:79], v[84:87], v[48:63]
    s_waitcnt vmcnt(8)
    ds_read_b128 v[84:87], v12 offset:27648
    ds_read_b64_tr_b16 v[72:73], v10 offset:28672
    ds_read_b64_tr_b16 v[74:75], v10 offset:29696
    ds_read_b64_tr_b16 v[76:77], v11 offset:28672
    ds_read_b64_tr_b16 v[78:79], v11 offset:29696
    s_waitcnt lgkmcnt(5)
    v_mfma_f32_32x32x16_bf16 v[32:47], v[64:67], v[80:83], v[32:47]
    v_mfma_f32_32x32x16_bf16 v[48:63], v[68:71], v[80:83], v[48:63]
    v_lshlrev_b32 v26, 4, v0
    s_add_u32 s54, s50, 1
    s_and_b32 s54, s54, 3
    s_lshl_b32 s55, s51, 2
    s_add_u32 s54, s54, s55
    s_lshl_b32 s54, s54, 3
    s_add_u32 s54, s54, s49
    s_lshl_b32 s54, s54, 2
    s_add_u32 s54, s54, s48
    s_mul_i32 s95, s54, 6144
    s_add_u32 s98, s95, 4096
    s_add_u32 s54, s50, 2
    s_and_b32 s54, s54, 3
    s_lshl_b32 s55, s51, 2
    s_add_u32 s54, s54, s55
    s_lshl_b32 s54, s54, 3
    s_add_u32 s54, s54, s49
    s_lshl_b32 s54, s54, 2
    s_add_u32 s54, s54, s48
    s_mul_i32 s96, s54, 6144
    s_add_u32 s99, s96, 4096
    s_add_u32 s54, s50, 3
    s_and_b32 s54, s54, 3
    s_lshl_b32 s55, s51, 2
    s_add_u32 s54, s54, s55
    s_lshl_b32 s54, s54, 3
    s_add_u32 s54, s54, s49
    s_lshl_b32 s54, s54, 2
    s_add_u32 s54, s54, s48
    s_mul_i32 s97, s54, 6144
    s_add_u32 s100, s97, 4096
    s_mov_b32 s101, 7
    v_mov_b32 v22, 2044
    buffer_load_dword v23, v22, s[36:39], s98 offen sc1
    buffer_load_dword v27, v22, s[36:39], s99 offen sc1
    buffer_load_dword v28, v22, s[36:39], s100 offen sc1
    s_waitcnt vmcnt(9)
    ds_read_b128 v[80:83], v12 offset:28672
    ds_read_b64_tr_b16 v[64:65], v10 offset:0
    ds_read_b64_tr_b16 v[66:67], v10 offset:1024
    ds_read_b64_tr_b16 v[68:69], v11 offset:0
    ds_read_b64_tr_b16 v[70:71], v11 offset:1024
    s_waitcnt lgkmcnt(5)
    v_mfma_f32_32x32x16_bf16 v[32:47], v[72:75], v[84:87], v[32:47]
    v_mfma_f32_32x32x16_bf16 v[48:63], v[76:79], v[84:87], v[48:63]
    s_waitcnt vmcnt(7)
    ds_read_b128 v[84:87], v12 offset:29696
    ds_read_b64_tr_b16 v[72:73], v10 offset:2048
    ds_read_b64_tr_b16 v[74:75], v10 offset:3072
    ds_read_b64_tr_b16 v[76:77], v11 offset:2048
    ds_read_b64_tr_b16 v[78:79], v11 offset:3072
    s_waitcnt lgkmcnt(5)
    v_mfma_f32_32x32x16_bf16 v[32:47], v[64:67], v[80:83], v[32:47]
    v_mfma_f32_32x32x16_bf16 v[48:63], v[68:71], v[80:83], v[48:63]
    s_waitcnt vmcnt(5)
    ds_read_b128 v[80:83], v12 offset:30720
    ds_read_b64_tr_b16 v[64:65], v10 offset:4096
    ds_read_b64_tr_b16 v[66:67], v10 offset:5120
    ds_read_b64_tr_b16 v[68:69], v11 offset:4096
    ds_read_b64_tr_b16 v[70:71], v11 offset:5120
    s_waitcnt lgkmcnt(5)
    v_mfma_f32_32x32x16_bf16 v[32:47], v[72:75], v[84:87], v[32:47]
    v_mfma_f32_32x32x16_bf16 v[48:63], v[76:79], v[84:87], v[48:63]
    s_waitcnt vmcnt(3)
    ds_read_b128 v[84:87], v12 offset:31744
    ds_read_b64_tr_b16 v[72:73], v10 offset:6144
    ds_read_b64_tr_b16 v[74:75], v10 offset:7168
    ds_read_b64_tr_b16 v[76:77], v11 offset:6144
    ds_read_b64_tr_b16 v[78:79], v11 offset:7168
    s_waitcnt lgkmcnt(5)
    v_mfma_f32_32x32x16_bf16 v[32:47], v[64:67], v[80:83], v[32:47]
    v_mfma_f32_32x32x16_bf16 v[48:63], v[68:71], v[80:83], v[48:63]
    s_waitcnt vmcnt(0)
    s_mov_b32 s56, 0
    v_readfirstlane_b32 s55, v23
    s_cmp_eq_u32 s55, s58
    s_cselect_b32 s55, 1, 0
    s_or_b32 s56, s56, s55
    v_readfirstlane_b32 s55, v27
    s_cmp_eq_u32 s55, s58
    s_cselect_b32 s55, 2, 0
    s_or_b32 s56, s56, s55
    v_readfirstlane_b32 s55, v28
    s_cmp_eq_u32 s55, s58
    s_cselect_b32 s55, 4, 0
    s_or_b32 s56, s56, s55
    s_and_b32 s56, s56, s101
    s_bitcmp1_b32 s56, 0
    s_cbranch_scc0 L_e1_sk0e
    buffer_load_dwordx4 v[224:227], v26, s[36:39], s95 offen offset:0 sc1
    buffer_load_dwordx4 v[228:231], v26, s[36:39], s95 offen offset:1024 sc1
    buffer_load_dwordx4 v[232:235], v26, s[36:39], s95 offen offset:2048 sc1
    buffer_load_dwordx4 v[236:239], v26, s[36:39], s95 offen offset:3072 sc1
    buffer_load_dwordx4 v[240:243], v26, s[36:39], s98 offen offset:0 sc1
    buffer_load_dwordx4 v[244:247], v26, s[36:39], s98 offen offset:1024 sc1
L_e1_sk0e:
    s_bitcmp1_b32 s56, 1
    s_cbranch_scc0 L_e1_sk1e
    buffer_load_dwordx4 v[248:251], v26, s[36:39], s96 offen offset:0 sc1
    buffer_load_dwordx4 v[252:255], v26, s[36:39], s96 offen offset:1024 sc1
    buffer_load_dwordx4 v[88:91], v26, s[36:39], s96 offen offset:2048 sc1
    buffer_load_dwordx4 v[92:95], v26, s[36:39], s96 offen offset:3072 sc1
    buffer_load_dwordx4 v[2:5], v26, s[36:39], s99 offen offset:0 sc1
    buffer_load_dwordx4 v[6:9], v26, s[36:39], s99 offen offset:1024 sc1
L_e1_sk1e:
    s_bitcmp1_b32 s56, 2
    s_cbranch_scc0 L_e1_sk2e
    buffer_load_dwordx4 a[0:3], v26, s[36:39], s97 offen offset:0 sc1
    buffer_load_dwordx4 a[4:7], v26, s[36:39], s97 offen offset:1024 sc1
    buffer_load_dwordx4 a[8:11], v26, s[36:39], s97 offen offset:2048 sc1
    buffer_load_dwordx4 a[12:15], v26, s[36:39], s97 offen offset:3072 sc1
    buffer_load_dwordx4 a[16:19], v26, s[36:39], s100 offen offset:0 sc1
    buffer_load_dwordx4 a[20:23], v26, s[36:39], s100 offen offset:1024 sc1
L_e1_sk2e:
    s_waitcnt lgkmcnt(0)
    v_mfma_f32_32x32x16_bf16 v[32:47], v[72:75], v[84:87], v[32:47]
    v_mfma_f32_32x32x16_bf16 v[48:63], v[76:79], v[84:87], v[48:63]
    s_lshl_b32 s54, s2, 2
    s_add_u32 s54, s54, s48
    s_mul_i32 s92, s54, 6144
    s_add_u32 s93, s92, 4096
    s_nop 7
    v_mov_b32 v67, s58
    v_mov_b32 v71, s58
    v_mov_b32 v75, s58
    v_mov_b32 v79, s58
    v_mov_b32 v83, s58
    v_mov_b32 v87, s58
    v_mov_b32 v85, v31
    v_mov_b32 v86, v30
    s_nop 3
    v_cvt_pk_bf16_f32 v64, v32, v33
    v_cvt_pk_bf16_f32 v65, v34, v35
    v_cvt_pk_bf16_f32 v66, v36, v37
    v_cvt_pk_bf16_f32 v68, v38, v39
    v_cvt_pk_bf16_f32 v69, v40, v41
    v_cvt_pk_bf16_f32 v70, v42, v43
    v_cvt_pk_bf16_f32 v72, v44, v45
    v_cvt_pk_bf16_f32 v73, v46, v47
    v_cvt_pk_bf16_f32 v74, v48, v49
    v_cvt_pk_bf16_f32 v76, v50, v51
    v_cvt_pk_bf16_f32 v77, v52, v53
    v_cvt_pk_bf16_f32 v78, v54, v55
    v_cvt_pk_bf16_f32 v80, v56, v57
    v_cvt_pk_bf16_f32 v81, v58, v59
    v_cvt_pk_bf16_f32 v82, v60, v61
    v_cvt_pk_bf16_f32 v84, v62, v63
    buffer_store_dwordx4 v[64:67], v26, s[36:39], s92 offen offset:0 sc1
    buffer_store_dwordx4 v[68:71], v26, s[36:39], s92 offen offset:1024 sc1
    buffer_store_dwordx4 v[72:75], v26, s[36:39], s92 offen offset:2048 sc1
    buffer_store_dwordx4 v[76:79], v26, s[36:39], s92 offen offset:3072 sc1
    buffer_store_dwordx4 v[80:83], v26, s[36:39], s93 offen offset:0 sc1
    buffer_store_dwordx4 v[84:87], v26, s[36:39], s93 offen offset:1024 sc1
    s_branch L_e1_chk
L_e1_retry:
    s_add_u32 s94, s94, 1
    s_cmp_ge_u32 s94, 0x40000
    s_cbranch_scc1 L_exitA
    s_bitcmp1_b32 s101, 0
    s_cbranch_scc0 L_e1_ps0r
    buffer_load_dword v23, v22, s[36:39], s98 offen sc1
L_e1_ps0r:
    s_bitcmp1_b32 s101, 1
    s_cbranch_scc0 L_e1_ps1r
    buffer_load_dword v27, v22, s[36:39], s99 offen sc1
L_e1_ps1r:
    s_bitcmp1_b32 s101, 2
    s_cbranch_scc0 L_e1_ps2r
    buffer_load_dword v28, v22, s[36:39], s100 offen sc1
L_e1_ps2r:
    s_waitcnt vmcnt(0)
    s_mov_b32 s56, 0
    v_readfirstlane_b32 s55, v23
    s_cmp_eq_u32 s55, s58
    s_cselect_b32 s55, 1, 0
    s_or_b32 s56, s56, s55
    v_readfirstlane_b32 s55, v27
    s_cmp_eq_u32 s55, s58
    s_cselect_b32 s55, 2, 0
    s_or_b32 s56, s56, s55
    v_readfirstlane_b32 s55, v28
    s_cmp_eq_u32 s55, s58
    s_cselect_b32 s55, 4, 0
    s_or_b32 s56, s56, s55
    s_and_b32 s56, s56, s101
    s_cbranch_scc0 L_e1_retry
    s_bitcmp1_b32 s56, 0
    s_cbranch_scc0 L_e1_sk0r
    buffer_load_dwordx4 v[224:227], v26, s[36:39], s95 offen offset:0 sc1
    buffer_load_dwordx4 v[228:231], v26, s[36:39], s95 offen offset:1024 sc1
    buffer_load_dwordx4 v[232:235], v26, s[36:39], s95 offen offset:2048 sc1
    buffer_load_dwordx4 v[236:239], v26, s[36:39], s95 offen offset:3072 sc1
    buffer_load_dwordx4 v[240:243], v26, s[36:39], s98 offen offset:0 sc1
    buffer_load_dwordx4 v[244:247], v26, s[36:39], s98 offen offset:1024 sc1
L_e1_sk0r:
    s_bitcmp1_b32 s56, 1
    s_cbranch_scc0 L_e1_sk1r
    buffer_load_dwordx4 v[248:251], v26, s[36:39], s96 offen offset:0 sc1
    buffer_load_dwordx4 v[252:255], v26, s[36:39], s96 offen offset:1024 sc1
    buffer_load_dwordx4 v[88:91], v26, s[36:39], s96 offen offset:2048 sc1
    buffer_load_dwordx4 v[92:95], v26, s[36:39], s96 offen offset:3072 sc1
    buffer_load_dwordx4 v[2:5], v26, s[36:39], s99 offen offset:0 sc1
    buffer_load_dwordx4 v[6:9], v26, s[36:39], s99 offen offset:1024 sc1
L_e1_sk1r:
    s_bitcmp1_b32 s56, 2
    s_cbranch_scc0 L_e1_sk2r
    buffer_load_dwordx4 a[0:3], v26, s[36:39], s97 offen offset:0 sc1
    buffer_load_dwordx4 a[4:7], v26, s[36:39], s97 offen offset:1024 sc1
    buffer_load_dwordx4 a[8:11], v26, s[36:39], s97 offen offset:2048 sc1
    buffer_load_dwordx4 a[12:15], v26, s[36:39], s97 offen offset:3072 sc1
    buffer_load_dwordx4 a[16:19], v26, s[36:39], s100 offen offset:0 sc1
    buffer_load_dwordx4 a[20:23], v26, s[36:39], s100 offen offset:1024 sc1
L_e1_sk2r:
L_e1_chk:
    s_waitcnt vmcnt(0)
    s_bitcmp1_b32 s56, 0
    s_cbranch_scc0 L_e1_ok0
    v_xor_b32 v227, s58, v227
    v_xor_b32 v231, s58, v231
    v_xor_b32 v235, s58, v235
    v_xor_b32 v239, s58, v239
    v_xor_b32 v243, s58, v243
    v_xor_b32 v247, s58, v247
    v_or3_b32 v27, v227, v231, v235
    v_or3_b32 v28, v239, v243, v247
    v_or_b32 v27, v27, v28
    v_cmp_ne_u32 vcc, 0, v27
    s_nop 3
    s_cbranch_vccnz L_e1_ok0
    s_bitset0_b32 s101, 0
L_e1_ok0:
    s_bitcmp1_b32 s56, 1
    s_cbranch_scc0 L_e1_ok1
    v_xor_b32 v251, s58, v251
    v_xor_b32 v255, s58, v255
    v_xor_b32 v91, s58, v91
    v_xor_b32 v95, s58, v95
    v_xor_b32 v5, s58, v5
    v_xor_b32 v9, s58, v9
    v_or3_b32 v27, v251, v255, v91
    v_or3_b32 v28, v95, v5, v9
    v_or_b32 v27, v27, v28
    v_cmp_ne_u32 vcc, 0, v27
    s_nop 3
    s_cbranch_vccnz L_e1_ok1
    s_bitset0_b32 s101, 1
L_e1_ok1:
    s_bitcmp1_b32 s56, 2
    s_cbranch_scc0 L_e1_ok2
    v_accvgpr_read_b32 v64, a0
    v_accvgpr_read_b32 v65, a1
    v_accvgpr_read_b32 v66, a2
    v_accvgpr_read_b32 v67, a3
    v_accvgpr_read_b32 v68, a4
    v_accvgpr_read_b32 v69, a5
    v_accvgpr_read_b32 v70, a6
    v_accvgpr_read_b32 v71, a7
    v_accvgpr_read_b32 v72, a8
    v_accvgpr_read_b32 v73, a9
    v_accvgpr_read_b32 v74, a10
    v_accvgpr_read_b32 v75, a11
    v_accvgpr_read_b32 v76, a12
    v_accvgpr_read_b32 v77, a13
    v_accvgpr_read_b32 v78, a14
    v_accvgpr_read_b32 v79, a15
    v_accvgpr_read_b32 v80, a16
    v_accvgpr_read_b32 v81, a17
    v_accvgpr_read_b32 v82, a18
    v_accvgpr_read_b32 v83, a19
    v_accvgpr_read_b32 v84, a20
    v_accvgpr_read_b32 v85, a21
    v_accvgpr_read_b32 v86, a22
    v_accvgpr_read_b32 v87, a23
    v_xor_b32 v67, s58, v67
    v_xor_b32 v71, s58, v71
    v_xor_b32 v75, s58, v75
    v_xor_b32 v79, s58, v79
    v_xor_b32 v83, s58, v83
    v_xor_b32 v87, s58, v87
    v_or3_b32 v27, v67, v71, v75
    v_or3_b32 v28, v79, v83, v87
    v_or_b32 v27, v27, v28
    v_cmp_ne_u32 vcc, 0, v27
    s_nop 3
    s_cbranch_vccnz L_e1_ok2
    s_bitset0_b32 s101, 2
L_e1_ok2:
    s_cmp_lg_u32 s101, 0
    s_cbranch_scc1 L_e1_retry
    v_max3_f32 v28, v31, v245, v7
    v_max_f32 v28, v28, v85
    v_sub_f32 v18, v31, v28
    v_sub_f32 v19, v245, v28
    v_sub_f32 v20, v7, v28
    v_sub_f32 v21, v85, v28
    v_exp_f32 v18, v18
    v_exp_f32 v19, v19
    v_exp_f32 v20, v20
    v_exp_f32 v21, v21
    s_nop 0
    v_mul_f32 v28, v18, v30
    v_fmac_f32 v28, v19, v246
    v_fmac_f32 v28, v20, v8
    v_fmac_f32 v28, v21, v86
    v_rcp_f32 v28, v28
    s_nop 0
    v_mul_f32 v18, v18, v28
    v_mul_f32 v19, v19, v28
    v_mul_f32 v20, v20, v28
    v_mul_f32 v21, v21, v28
    s_mov_b32 s56, 0xffff0000
    v_mul_f32 v32, v32, v18
    v_mul_f32 v33, v33, v18
    v_mul_f32 v34, v34, v18
    v_mul_f32 v35, v35, v18
    v_mul_f32 v36, v36, v18
    v_mul_f32 v37, v37, v18
    v_mul_f32 v38, v38, v18
    v_mul_f32 v39, v39, v18
    v_mul_f32 v40, v40, v18
    v_mul_f32 v41, v41, v18
    v_mul_f32 v42, v42, v18
    v_mul_f32 v43, v43, v18
    v_mul_f32 v44, v44, v18
    v_mul_f32 v45, v45, v18
    v_mul_f32 v46, v46, v18
    v_mul_f32 v47, v47, v18
    v_mul_f32 v48, v48, v18
    v_mul_f32 v49, v49, v18
    v_mul_f32 v50, v50, v18
    v_mul_f32 v51, v51, v18
    v_mul_f32 v52, v52, v18
    v_mul_f32 v53, v53, v18
    v_mul_f32 v54, v54, v18
    v_mul_f32 v55, v55, v18
    v_mul_f32 v56, v56, v18
    v_mul_f32 v57, v57, v18
    v_mul_f32 v58, v58, v18
    v_mul_f32 v59, v59, v18
    v_mul_f32 v60, v60, v18
    v_mul_f32 v61, v61, v18
    v_mul_f32 v62, v62, v18
    v_mul_f32 v63, v63, v18
    v_lshlrev_b32 v28, 16, v224
    v_and_b32 v29, s56, v224
    v_fmac_f32 v32, v28, v19
    v_fmac_f32 v33, v29, v19
    v_lshlrev_b32 v28, 16, v225
    v_and_b32 v29, s56, v225
    v_fmac_f32 v34, v28, v19
    v_fmac_f32 v35, v29, v19
    v_lshlrev_b32 v28, 16, v226
    v_and_b32 v29, s56, v226
    v_fmac_f32 v36, v28, v19
    v_fmac_f32 v37, v29, v19
    v_lshlrev_b32 v28, 16, v228
    v_and_b32 v29, s56, v228
    v_fmac_f32 v38, v28, v19
    v_fmac_f32 v39, v29, v19
    v_lshlrev_b32 v28, 16, v229
    v_and_b32 v29, s56, v229
    v_fmac_f32 v40, v28, v19
    v_fmac_f32 v41, v29, v19
    v_lshlrev_b32 v28, 16, v230
    v_and_b32 v29, s56, v230
    v_fmac_f32 v42, v28, v19
    v_fmac_f32 v43, v29, v19
    v_lshlrev_b32 v28, 16, v232
    v_and_b32 v29, s56, v232
    v_fmac_f32 v44, v28, v19
    v_fmac_f32 v45, v29, v19
    v_lshlrev_b32 v28, 16, v233
    v_and_b32 v29, s56, v233
    v_fmac_f32 v46, v28, v19
    v_fmac_f32 v47, v29, v19
    v_lshlrev_b32 v28, 16, v234
    v_and_b32 v29, s56, v234
    v_fmac_f32 v48, v28, v19
    v_fmac_f32 v49, v29, v19
    v_lshlrev_b32 v28, 16, v236
    v_and_b32 v29, s56, v236
    v_fmac_f32 v50, v28, v19
    v_fmac_f32 v51, v29, v19
    v_lshlrev_b32 v28, 16, v237
    v_and_b32 v29, s56, v237
    v_fmac_f32 v52, v28, v19
    v_fmac_f32 v53, v29, v19
    v_lshlrev_b32 v28, 16, v238
    v_and_b32 v29, s56, v238
    v_fmac_f32 v54, v28, v19
    v_fmac_f32 v55, v29, v19
    v_lshlrev_b32 v28, 16, v240
    v_and_b32 v29, s56, v240
    v_fmac_f32 v56, v28, v19
    v_fmac_f32 v57, v29, v19
    v_lshlrev_b32 v28, 16, v241
    v_and_b32 v29, s56, v241
    v_fmac_f32 v58, v28, v19
    v_fmac_f32 v59, v29, v19
    v_lshlrev_b32 v28, 16, v242
    v_and_b32 v29, s56, v242
    v_fmac_f32 v60, v28, v19
    v_fmac_f32 v61, v29, v19
    v_lshlrev_b32 v28, 16, v244
    v_and_b32 v29, s56, v244
    v_fmac_f32 v62, v28, v19
    v_fmac_f32 v63, v29, v19
    v_lshlrev_b32 v28, 16, v248
    v_and_b32 v29, s56, v248
    v_fmac_f32 v32, v28, v20
    v_fmac_f32 v33, v29, v20
    v_lshlrev_b32 v28, 16, v249
    v_and_b32 v29, s56, v249
    v_fmac_f32 v34, v28, v20
    v_fmac_f32 v35, v29, v20
    v_lshlrev_b32 v28, 16, v250
    v_and_b32 v29, s56, v250
    v_fmac_f32 v36, v28, v20
    v_fmac_f32 v37, v29, v20
    v_lshlrev_b32 v28, 16, v252
    v_and_b32 v29, s56, v252
    v_fmac_f32 v38, v28, v20
    v_fmac_f32 v39, v29, v20
    v_lshlrev_b32 v28, 16, v253
    v_and_b32 v29, s56, v253
    v_fmac_f32 v40, v28, v20
    v_fmac_f32 v41, v29, v20
    v_lshlrev_b32 v28, 16, v254
    v_and_b32 v29, s56, v254
    v_fmac_f32 v42, v28, v20
    v_fmac_f32 v43, v29, v20
    v_lshlrev_b32 v28, 16, v88
    v_and_b32 v29, s56, v88
    v_fmac_f32 v44, v28, v20
    v_fmac_f32 v45, v29, v20
    v_lshlrev_b32 v28, 16, v89
    v_and_b32 v29, s56, v89
    v_fmac_f32 v46, v28, v20
    v_fmac_f32 v47, v29, v20
    v_lshlrev_b32 v28, 16, v90
    v_and_b32 v29, s56, v90
    v_fmac_f32 v48, v28, v20
    v_fmac_f32 v49, v29, v20
    v_lshlrev_b32 v28, 16, v92
    v_and_b32 v29, s56, v92
    v_fmac_f32 v50, v28, v20
    v_fmac_f32 v51, v29, v20
    v_lshlrev_b32 v28, 16, v93
    v_and_b32 v29, s56, v93
    v_fmac_f32 v52, v28, v20
    v_fmac_f32 v53, v29, v20
    v_lshlrev_b32 v28, 16, v94
    v_and_b32 v29, s56, v94
    v_fmac_f32 v54, v28, v20
    v_fmac_f32 v55, v29, v20
    v_lshlrev_b32 v28, 16, v2
    v_and_b32 v29, s56, v2
    v_fmac_f32 v56, v28, v20
    v_fmac_f32 v57, v29, v20
    v_lshlrev_b32 v28, 16, v3
    v_and_b32 v29, s56, v3
    v_fmac_f32 v58, v28, v20
    v_fmac_f32 v59, v29, v20
    v_lshlrev_b32 v28, 16, v4
    v_and_b32 v29, s56, v4
    v_fmac_f32 v60, v28, v20
    v_fmac_f32 v61, v29, v20
    v_lshlrev_b32 v28, 16, v6
    v_and_b32 v29, s56, v6
    v_fmac_f32 v62, v28, v20
    v_fmac_f32 v63, v29, v20
    v_lshlrev_b32 v28, 16, v64
    v_and_b32 v29, s56, v64
    v_fmac_f32 v32, v28, v21
    v_fmac_f32 v33, v29, v21
    v_lshlrev_b32 v28, 16, v65
    v_and_b32 v29, s56, v65
    v_fmac_f32 v34, v28, v21
    v_fmac_f32 v35, v29, v21
    v_lshlrev_b32 v28, 16, v66
    v_and_b32 v29, s56, v66
    v_fmac_f32 v36, v28, v21
    v_fmac_f32 v37, v29, v21
    v_lshlrev_b32 v28, 16, v68
    v_and_b32 v29, s56, v68
    v_fmac_f32 v38, v28, v21
    v_fmac_f32 v39, v29, v21
    v_lshlrev_b32 v28, 16, v69
    v_and_b32 v29, s56, v69
    v_fmac_f32 v40, v28, v21
    v_fmac_f32 v41, v29, v21
    v_lshlrev_b32 v28, 16, v70
    v_and_b32 v29, s56, v70
    v_fmac_f32 v42, v28, v21
    v_fmac_f32 v43, v29, v21
    v_lshlrev_b32 v28, 16, v72
    v_and_b32 v29, s56, v72
    v_fmac_f32 v44, v28, v21
    v_fmac_f32 v45, v29, v21
    v_lshlrev_b32 v28, 16, v73
    v_and_b32 v29, s56, v73
    v_fmac_f32 v46, v28, v21
    v_fmac_f32 v47, v29, v21
    v_lshlrev_b32 v28, 16, v74
    v_and_b32 v29, s56, v74
    v_fmac_f32 v48, v28, v21
    v_fmac_f32 v49, v29, v21
    v_lshlrev_b32 v28, 16, v76
    v_and_b32 v29, s56, v76
    v_fmac_f32 v50, v28, v21
    v_fmac_f32 v51, v29, v21
    v_lshlrev_b32 v28, 16, v77
    v_and_b32 v29, s56, v77
    v_fmac_f32 v52, v28, v21
    v_fmac_f32 v53, v29, v21
    v_lshlrev_b32 v28, 16, v78
    v_and_b32 v29, s56, v78
    v_fmac_f32 v54, v28, v21
    v_fmac_f32 v55, v29, v21
    v_lshlrev_b32 v28, 16, v80
    v_and_b32 v29, s56, v80
    v_fmac_f32 v56, v28, v21
    v_fmac_f32 v57, v29, v21
    v_lshlrev_b32 v28, 16, v81
    v_and_b32 v29, s56, v81
    v_fmac_f32 v58, v28, v21
    v_fmac_f32 v59, v29, v21
    v_lshlrev_b32 v28, 16, v82
    v_and_b32 v29, s56, v82
    v_fmac_f32 v60, v28, v21
    v_fmac_f32 v61, v29, v21
    v_lshlrev_b32 v28, 16, v84
    v_and_b32 v29, s56, v84
    v_fmac_f32 v62, v28, v21
    v_fmac_f32 v63, v29, v21
    v_cvt_pk_bf16_f32 v64, v32, v33
    v_cvt_pk_bf16_f32 v65, v34, v35
    v_cvt_pk_bf16_f32 v66, v36, v37
    v_cvt_pk_bf16_f32 v67, v38, v39
    v_cvt_pk_bf16_f32 v68, v40, v41
    v_cvt_pk_bf16_f32 v69, v42, v43
    v_cvt_pk_bf16_f32 v70, v44, v45
    v_cvt_pk_bf16_f32 v71, v46, v47
    v_cvt_pk_bf16_f32 v72, v48, v49
    v_cvt_pk_bf16_f32 v73, v50, v51
    v_cvt_pk_bf16_f32 v74, v52, v53
    v_cvt_pk_bf16_f32 v75, v54, v55
    v_cvt_pk_bf16_f32 v76, v56, v57
    v_cvt_pk_bf16_f32 v77, v58, v59
    v_cvt_pk_bf16_f32 v78, v60, v61
    v_cvt_pk_bf16_f32 v79, v62, v63
    s_nop 1
    v_mfma_f32_16x16x32_bf16 v[32:35], v[96:99], v[64:67], 0
    v_mfma_f32_16x16x32_bf16 v[36:39], v[100:103], v[64:67], 0
    v_mfma_f32_16x16x32_bf16 v[40:43], v[104:107], v[64:67], 0
    v_mfma_f32_16x16x32_bf16 v[44:47], v[108:111], v[64:67], 0
    v_mfma_f32_16x16x32_bf16 v[48:51], v[112:115], v[64:67], 0
    v_mfma_f32_16x16x32_bf16 v[52:55], v[116:119], v[64:67], 0
    v_mfma_f32_16x16x32_bf16 v[56:59], v[120:123], v[64:67], 0
    v_mfma_f32_16x16x32_bf16 v[60:63], v[124:127], v[64:67], 0
    v_mfma_f32_16x16x32_bf16 v[32:35], v[128:131], v[68:71], v[32:35]
    v_mfma_f32_16x16x32_bf16 v[36:39], v[132:135], v[68:71], v[36:39]
    v_mfma_f32_16x16x32_bf16 v[40:43], v[136:139], v[68:71], v[40:43]
    v_mfma_f32_16x16x32_bf16 v[44:47], v[140:143], v[68:71], v[44:47]
    v_mfma_f32_16x16x32_bf16 v[48:51], v[144:147], v[68:71], v[48:51]
    v_mfma_f32_16x16x32_bf16 v[52:55], v[148:151], v[68:71], v[52:55]
    v_mfma_f32_16x16x32_bf16 v[56:59], v[152:155], v[68:71], v[56:59]
    v_mfma_f32_16x16x32_bf16 v[60:63], v[156:159], v[68:71], v[60:63]
    v_mfma_f32_16x16x32_bf16 v[32:35], v[160:163], v[72:75], v[32:35]
    v_mfma_f32_16x16x32_bf16 v[36:39], v[164:167], v[72:75], v[36:39]
    v_mfma_f32_16x16x32_bf16 v[40:43], v[168:171], v[72:75], v[40:43]
    v_mfma_f32_16x16x32_bf16 v[44:47], v[172:175], v[72:75], v[44:47]
    v_mfma_f32_16x16x32_bf16 v[48:51], v[176:179], v[72:75], v[48:51]
    v_mfma_f32_16x16x32_bf16 v[52:55], v[180:183], v[72:75], v[52:55]
    v_mfma_f32_16x16x32_bf16 v[56:59], v[184:187], v[72:75], v[56:59]
    v_mfma_f32_16x16x32_bf16 v[60:63], v[188:191], v[72:75], v[60:63]
    v_mfma_f32_16x16x32_bf16 v[32:35], v[192:195], v[76:79], v[32:35]
    v_mfma_f32_16x16x32_bf16 v[36:39], v[196:199], v[76:79], v[36:39]
    v_mfma_f32_16x16x32_bf16 v[40:43], v[200:203], v[76:79], v[40:43]
    v_mfma_f32_16x16x32_bf16 v[44:47], v[204:207], v[76:79], v[44:47]
    v_mfma_f32_16x16x32_bf16 v[48:51], v[208:211], v[76:79], v[48:51]
    v_mfma_f32_16x16x32_bf16 v[52:55], v[212:215], v[76:79], v[52:55]
    v_mfma_f32_16x16x32_bf16 v[56:59], v[216:219], v[76:79], v[56:59]
    v_mfma_f32_16x16x32_bf16 v[60:63], v[220:223], v[76:79], v[60:63]
    v_add_u32 v27, s52, v26
    v_bfe_u32 v28, v0, 1, 3
    v_lshlrev_b32 v28, 14, v28
    v_lshrrev_b32 v29, 4, v0
    v_lshl_add_u32 v28, v29, 5, v28
    v_and_b32 v29, 1, v0
    v_lshl_add_u32 v25, v29, 4, v28
    s_nop 1
    ds_write_b128 v27, v[32:35] offset:0
    ds_write_b128 v27, v[36:39] offset:1024
    ds_write_b128 v27, v[40:43] offset:2048
    ds_write_b128 v27, v[44:47] offset:3072
    ds_write_b128 v27, v[48:51] offset:4096
    ds_write_b128 v27, v[52:55] offset:5120
    ds_write_b128 v27, v[56:59] offset:6144
    ds_write_b128 v27, v[60:63] offset:7168
    s_waitcnt lgkmcnt(0)
    s_barrier
    s_lshl_b32 s54, s48, 11
    v_add_u32 v27, s54, v26
    ds_read_b128 v[32:35], v27 offset:0
    ds_read_b128 v[36:39], v27 offset:30720
    ds_read_b128 v[40:43], v27 offset:61440
    ds_read_b128 v[48:51], v27 offset:1024
    ds_read_b128 v[52:55], v27 offset:31744
    ds_read_b128 v[56:59], v27 offset:62464
    v_add_u32 v28, 92160, v27
    ds_read_b128 v[44:47], v28 offset:0
    ds_read_b128 v[60:63], v28 offset:1024
    s_lshl_b32 s54, s51, 2
    s_add_u32 s54, s54, s50
    s_lshl_b32 s54, s54, 17
    s_add_u32 s54, s54, 0xa00000
    s_lshl_b32 s55, s48, 12
    s_add_u32 s54, s54, s55
    s_lshl_b32 s55, s49, 7
    s_add_u32 s55, s55, s54
    s_lshl_b32 s56, s49, 14
    s_add_u32 s93, s56, s54
    s_waitcnt lgkmcnt(0)
    v_add_f32 v32, v32, v36
    v_add_f32 v40, v40, v44
    v_add_f32 v33, v33, v37
    v_add_f32 v41, v41, v45
    v_add_f32 v34, v34, v38
    v_add_f32 v42, v42, v46
    v_add_f32 v35, v35, v39
    v_add_f32 v43, v43, v47
    v_add_f32 v64, v32, v40
    v_add_f32 v66, v33, v41
    v_add_f32 v68, v34, v42
    v_add_f32 v70, v35, v43
    v_add_f32 v48, v48, v52
    v_add_f32 v56, v56, v60
    v_add_f32 v49, v49, v53
    v_add_f32 v57, v57, v61
    v_add_f32 v50, v50, v54
    v_add_f32 v58, v58, v62
    v_add_f32 v51, v51, v55
    v_add_f32 v59, v59, v63
    v_add_f32 v72, v48, v56
    v_add_f32 v74, v49, v57
    v_add_f32 v76, v50, v58
    v_add_f32 v78, v51, v59
    v_mov_b32 v65, s58
    v_mov_b32 v67, s59
    v_mov_b32 v69, s58
    v_mov_b32 v71, s59
    v_mov_b32 v73, s58
    v_mov_b32 v75, s59
    v_mov_b32 v77, s58
    v_mov_b32 v79, s59
    buffer_store_dwordx4 v[64:67], v25, s[36:39], s55 offen offset:0 sc1
    buffer_store_dwordx4 v[68:71], v25, s[36:39], s55 offen offset:1024 sc1
    buffer_store_dwordx4 v[72:75], v25, s[36:39], s55 offen offset:2048 sc1
    buffer_store_dwordx4 v[76:79], v25, s[36:39], s55 offen offset:3072 sc1
    v_and_b32 v28, 1, v0
    s_lshl_b32 s56, s49, 1
    v_add_u32 v28, s56, v28
    v_mul_u32_u24 v28, 896, v28
    v_bfe_u32 v29, v0, 1, 2
    v_lshl_add_u32 v28, v29, 6, v28
    v_bfe_u32 v30, v0, 5, 1
    v_bfe_u32 v31, v0, 4, 1
    v_lshl_add_u32 v30, v30, 1, v31
    v_lshl_add_u32 v28, v30, 4, v28
    s_mul_i32 s56, s51, 14336
    s_add_u32 s57, s50, 2
    s_and_b32 s57, s57, 3
    s_lshl_b32 s57, s57, 8
    s_add_u32 s56, s56, s57
    s_lshl_b32 s57, s48, 2
    s_add_u32 s56, s56, s57
    v_add_u32 v24, s56, v28
    v_lshl_add_u32 v29, v29, 2, v30
    v_bfe_u32 v31, v0, 3, 1
    v_lshl_add_u32 v29, v31, 4, v29
    v_mov_b32 v31, 0x40000000
    s_cmp_eq_u32 s50, 1
    s_cselect_b32 s57, 8, 16
    v_cmp_le_u32 vcc, s57, v29
    s_nop 1
    v_cndmask_b32 v24, v24, v31, vcc
L_e2_retry:
    s_add_u32 s94, s94, 1
    s_cmp_ge_u32 s94, 0x40000
    s_cbranch_scc1 L_exitA
    buffer_load_dwordx4 v[80:83], v26, s[36:39], s93 offen offset:0 sc1
    buffer_load_dwordx4 v[84:87], v26, s[36:39], s93 offen offset:1024 sc1
    buffer_load_dwordx4 v[88:91], v26, s[36:39], s93 offen offset:2048 sc1
    buffer_load_dwordx4 v[92:95], v26, s[36:39], s93 offen offset:3072 sc1
    s_mov_b64 exec, -1
    s_waitcnt vmcnt(0)
    v_xor_b32 v28, s58, v81
    v_xor_b32 v29, s59, v83
    v_or_b32 v27, v28, v29
    v_xor_b32 v28, s58, v85
    v_xor_b32 v29, s59, v87
    v_or3_b32 v27, v27, v28, v29
    v_xor_b32 v28, s58, v89
    v_xor_b32 v29, s59, v91
    v_or3_b32 v27, v27, v28, v29
    v_xor_b32 v28, s58, v93
    v_xor_b32 v29, s59, v95
    v_or3_b32 v27, v27, v28, v29
    v_cmp_ne_u32 vcc, 0, v27
    s_nop 3
    s_and_b64 exec, vcc, vcc
    s_cbranch_scc1 L_e2_retry
    s_mov_b64 exec, -1
    v_permlane32_swap_b32 v80, v84
    v_permlane32_swap_b32 v82, v86
    v_permlane32_swap_b32 v88, v92
    v_permlane32_swap_b32 v90, v94
    s_nop 1
    v_add_f32 v80, v80, v84
    v_add_f32 v82, v82, v86
    v_add_f32 v88, v88, v92
    v_add_f32 v90, v90, v94
    s_nop 1
    v_permlane16_swap_b32 v80, v82
    v_permlane16_swap_b32 v88, v90
    s_nop 1
    v_add_f32 v80, v80, v82
    v_add_f32 v88, v88, v90
    s_nop 1
    v_add_f32_dpp v82, v80, v80 row_ror:8 row_mask:0xf bank_mask:0xf
    v_add_f32_dpp v90, v88, v88 row_ror:8 row_mask:0xf bank_mask:0xf
    s_nop 1
    v_cvt_pk_bf16_f32 v30, v82, v90
    buffer_store_dword v30, v24, s[44:47], 0 offen
    s_and_b32 s54, s2, 31
    s_or_b32 s54, s54, s48
    s_cmp_lg_u32 s54, 0
    s_cbranch_scc1 L_nobump
    v_mov_b32 v30, s58
    v_mov_b32 v31, 0
    s_lshl_b32 s54, s51, 8
    s_add_u32 s54, s54, 0x1000000
    s_mov_b64 exec, 1
    buffer_store_dword v30, v31, s[36:39], s54 offen sc1
L_nobump:
    s_waitcnt vmcnt(0)
L_exitA:
    s_endpgm
.section .rodata,"a"
.p2align 6
.amdhsa_kernel standalone__gqa_block_cached__sampling_kernel
  .amdhsa_next_free_vgpr 512
  .amdhsa_next_free_sgpr 102
  .amdhsa_accum_offset 256
  .amdhsa_group_segment_fixed_size 0
  .amdhsa_kernarg_size 64
  .amdhsa_user_sgpr_count 2
  .amdhsa_user_sgpr_kernarg_segment_ptr 1
  .amdhsa_system_sgpr_workgroup_id_x 1
.end_amdhsa_kernel
```
